```python
import torch

def _softmax(x, axis=-1):
    return torch.softmax(x, dim=axis)

def _gelu(x):
    return torch.nn.functional.gelu(x, approximate='tanh')

def _silu(x):
    return torch.nn.functional.silu(x)

def _sigmoid(x):
    return torch.sigmoid(x)

def _layernorm(x, axis=-1, eps=1e-05):
    m = x.mean(dim=axis, keepdim=True)
    v = x.var(dim=axis, keepdim=True, unbiased=False)
    return (x - m) / torch.sqrt(v + eps)

def _scatter_add(tgt, idx, src, axis=0):
    return tgt.clone().index_add_(axis, idx, src)

def _segment_sum(src, seg, n):
    out = torch.zeros((n,) + src.shape[1:], dtype=src.dtype)
    return out.index_add_(0, seg, src)

def _pad(x, pw):
    flat = tuple((v for pair in reversed(pw) for v in pair))
    return torch.nn.functional.pad(x, flat)
kernel_name = 'adaLN_cond__gqa_block_cached__glu_gated_geglu__decode'

def setup_inputs():

    _w = lambda a: (lambda t: t.to(torch.bfloat16) if t.is_floating_point() else t)(torch.as_tensor(a))

    def _A_setup():
        B, Sq, D = (2, 1, 512)
        Hq, Hkv, Sk, Dh = (32, 8, 32768, 128)
        assert Hq % Hkv == 0, (Hq, Hkv)
        return {'x': _w((lambda *s: torch.randn(*s, dtype=torch.bfloat16) * 0.05)(B, Sq, D)), 'k_cache': _w((lambda *s: torch.randn(*s, dtype=torch.bfloat16) * 0.8)(B, Hkv, Sk, Dh)), 'v_cache': _w((lambda *s: torch.randn(*s, dtype=torch.bfloat16) * 3.2)(B, Hkv, Sk, Dh)), 'wq': _w((lambda *s: torch.randn(*s, dtype=torch.bfloat16) * 0.8)(D, Hq * Dh) * D ** (-0.5)), 'wo': _w((lambda *s: torch.randn(*s, dtype=torch.bfloat16) * 3.2)(Hq * Dh, D) * (Hq * Dh) ** (-0.5))}
    _A_in = _A_setup()

    def _B_setup():
        B, S, Dm, Df = (2, 1, 512, 1792)
        return {'x': _w((lambda *s: torch.randn(*s, dtype=torch.bfloat16) * 0.05)(B, S, Dm)), 'w_gate': _w((lambda *s: torch.randn(*s, dtype=torch.bfloat16) * 3.2)(Dm, Df) * Dm ** (-0.5)), 'w_up': _w((lambda *s: torch.randn(*s, dtype=torch.bfloat16) * 3.2)(Dm, Df) * Dm ** (-0.5)), 'w_down': _w((lambda *s: torch.randn(*s, dtype=torch.bfloat16) * 3.2)(Df, Dm) * Df ** (-0.5))}
    _B_in = _B_setup()
    return {'A_x': _A_in['x'], 'A_k_cache': _A_in['k_cache'], 'A_v_cache': _A_in['v_cache'], 'A_wq': _A_in['wq'], 'A_wo': _A_in['wo'], 'B_x': _B_in['x'], 'B_w_gate': _B_in['w_gate'], 'B_w_up': _B_in['w_up'], 'B_w_down': _B_in['w_down'], 'c': _w((lambda *s: torch.randn(*s, dtype=torch.bfloat16) * 0.4)(2, 512) * 8.0), 'w_mod': _w((lambda *s: torch.randn(*s, dtype=torch.bfloat16) * 0.4)(512, 6 * 512) * 512 ** (-0.5) * 8.0)}

def reference(A_x, A_k_cache, A_v_cache, A_wq, A_wo, B_x, B_w_gate, B_w_up, B_w_down, c, w_mod):

    def _A_ref(x, k_cache, v_cache, wq, wo):
        B, Sq, D = x.shape
        Hq, Dh = (32, 128)
        Hkv = k_cache.shape[1]
        rep = Hq // Hkv
        q = (lambda x, *d: x.permute(*d))((x @ wq).reshape(B, Sq, Hq, Dh), 0, 2, 1, 3)
        k = (lambda x, n, axis: torch.repeat_interleave(x, n, dim=axis))(k_cache, rep, axis=1)
        v = (lambda x, n, axis: torch.repeat_interleave(x, n, dim=axis))(v_cache, rep, axis=1)
        scores = torch.einsum('bhqd,bhkd->bhqk', q, k) * Dh ** (-0.5)
        p = _softmax(scores, axis=-1)
        o = torch.einsum('bhqk,bhkd->bhqd', p, v)
        return (lambda x, *d: x.permute(*d))(o, 0, 2, 1, 3).reshape(B, Sq, Hq * Dh) @ wo

    def _B_ref(x, w_gate, w_up, w_down):
        g = torch.einsum('bsd,df->bsf', x, w_gate)
        u = torch.einsum('bsd,df->bsf', x, w_up)
        h = _gelu(g) * u
        return torch.einsum('bsf,fd->bsd', h, w_down)
    x = A_x
    mod = (_silu(c) @ w_mod).reshape(c.shape[0], 6, 1, -1)
    sa, ca, ga, sb, cb, gb = (mod[:, 0].clone(), mod[:, 1].clone(), mod[:, 2].clone(), mod[:, 3].clone(), mod[:, 4].clone(), mod[:, 5].clone())
    h = _layernorm(x, axis=-1) * (1 + ca) + sa
    x = x + ga * _A_ref(h, A_k_cache, A_v_cache, A_wq, A_wo)
    h = _layernorm(x, axis=-1) * (1 + cb) + sb
    x = x + gb * _B_ref(h, B_w_gate, B_w_up, B_w_down)
    return x
```

```asm
; @launch grid=(256,1,1) block=(512,1,1) lds=163840
.amdgcn_target "amdgcn-amd-amdhsa--gfx950"
.text
.globl adaLN_cond__gqa_block_cached__glu_gated_geglu__decode_kernel
.p2align 8
.type adaLN_cond__gqa_block_cached__glu_gated_geglu__decode_kernel,@function
adaLN_cond__gqa_block_cached__glu_gated_geglu__decode_kernel:
  s_getpc_b64 s[24:25]
  s_cmp_ge_u32 s2, 256
  s_cbranch_scc1 L_end
  s_load_dwordx16 s[32:47], s[0:1], 0
  s_load_dwordx8 s[48:55], s[0:1], 64
  s_load_dwordx4 s[56:59], s[0:1], 96
  v_lshrrev_b32 v1, 6, v0
  v_and_b32 v0, 63, v0
  v_readfirstlane_b32 s3, v1
  s_lshr_b32 s62, s2, 4
  s_add_u32 s61, s2, s62
  s_and_b32 s61, s61, 15
  s_cmp_lt_u32 s2, 48
  s_cbranch_scc1 L_p1wg
  s_cmp_lt_u32 s2, 112
  s_cbranch_scc1 L_p2wg
  s_bfe_u32 s63, s2, 0x10003
  s_and_b32 s64, s2, 7
  s_mov_b32 s71, 0x05040100
  s_mov_b32 s72, 0x07060302
  s_mov_b32 s73, 0x3fb8aa3b
  s_mov_b32 s74, 0x3db504f3
  s_mov_b32 s79, 0xffff0000
  s_lshl_b32 s65, s61, 12
  s_add_u32 s65, s65, 65536
  s_lshl_b32 s67, s61, 23
  v_mov_b32 v5, 0
  v_and_b32 v78, 3, v0
  v_lshlrev_b32 v78, 2, v78
  v_bfe_u32 v79, v0, 2, 1
  v_add_u32 v78, v78, v79
  v_lshlrev_b32 v78, 8, v78
  v_lshrrev_b32 v79, 3, v0
  v_lshl_add_u32 v86, v79, 4, v78
  v_add_u32 v87, 4096, v86
  v_and_b32 v78, 3, v0
  v_lshlrev_b32 v78, 2, v78
  v_bfe_u32 v79, v0, 2, 2
  v_add_u32 v78, v78, v79
  v_lshlrev_b32 v78, 8, v78
  v_lshrrev_b32 v79, 4, v0
  v_lshl_add_u32 v1, v79, 4, v78
  v_add_u32 v2, 4096, v1
  v_lshlrev_b32 v3, 4, v0
  v_add_u32 v4, 4096, v3
  s_mov_b32 s29, 245824
  s_cmp_eq_u32 s62, 0
  s_cselect_b32 s29, 60, s29
  s_cmp_eq_u32 s62, 1
  s_cselect_b32 s29, 16442, s29
  s_cmp_eq_u32 s62, 2
  s_cselect_b32 s29, 32826, s29
  s_cmp_eq_u32 s62, 3
  s_cselect_b32 s29, 49208, s29
  s_cmp_eq_u32 s62, 4
  s_cselect_b32 s29, 65592, s29
  s_cmp_eq_u32 s62, 5
  s_cselect_b32 s29, 81976, s29
  s_cmp_eq_u32 s62, 6
  s_cselect_b32 s29, 98358, s29
  s_cmp_eq_u32 s62, 7
  s_cselect_b32 s29, 114744, s29
  s_cmp_eq_u32 s62, 8
  s_cselect_b32 s29, 131130, s29
  s_cmp_eq_u32 s62, 9
  s_cselect_b32 s29, 147520, s29
  s_cmp_eq_u32 s62, 10
  s_cselect_b32 s29, 163904, s29
  s_cmp_eq_u32 s62, 11
  s_cselect_b32 s29, 180288, s29
  s_cmp_eq_u32 s62, 12
  s_cselect_b32 s29, 196672, s29
  s_cmp_eq_u32 s62, 13
  s_cselect_b32 s29, 213056, s29
  s_cmp_eq_u32 s62, 14
  s_cselect_b32 s29, 229440, s29
  s_and_b32 s28, s29, 255
  s_lshr_b32 s29, s29, 8
  s_lshr_b32 s28, s28, 1
  s_mov_b64 s[100:101], -1
  s_waitcnt lgkmcnt(0)
  s_add_u32 s8, s34, s67
  s_addc_u32 s9, s35, 0
  s_mov_b32 s10, 8388608
  s_mov_b32 s11, 0x20000
  s_add_u32 s12, s36, s67
  s_addc_u32 s13, s37, 0
  s_mov_b32 s14, 8388608
  s_mov_b32 s15, 0x20000
  s_add_u32 s16, s58, 0x1fbfffff
  s_addc_u32 s17, s59, 0
  s_and_b32 s16, s16, 0xffe00000
  s_mov_b32 s18, 851968
  s_mov_b32 s19, 0x20000
  s_cmp_eq_u32 s3, 0
  s_cbranch_scc1 L_qpoll
  s_mov_b32 s66, 2
  s_barrier
  s_mov_b32 s66, 1
L_pref:
  s_sub_u32 s77, s3, 1
  s_lshl_b32 s67, s77, 1
  s_add_u32 s67, s67, s29
  s_lshl_b32 s67, s67, 13
  s_add_u32 s69, s67, 114688
  s_add_u32 s68, s67, 8192
  s_add_u32 s70, s69, 8192
  buffer_load_dwordx4 v[96:99], v86, s[8:11], s67 offen offset:0 nt
  buffer_load_dwordx4 v[100:103], v86, s[8:11], s67 offen offset:128 nt
  buffer_load_dwordx4 v[104:107], v86, s[8:11], s67 offen offset:512 nt
  buffer_load_dwordx4 v[108:111], v86, s[8:11], s67 offen offset:640 nt
  buffer_load_dwordx4 v[112:115], v87, s[8:11], s67 offen offset:0 nt
  buffer_load_dwordx4 v[116:119], v87, s[8:11], s67 offen offset:128 nt
  buffer_load_dwordx4 v[120:123], v87, s[8:11], s67 offen offset:512 nt
  buffer_load_dwordx4 v[124:127], v87, s[8:11], s67 offen offset:640 nt
  buffer_load_dwordx4 v[128:131], v86, s[8:11], s68 offen offset:0 nt
  buffer_load_dwordx4 v[132:135], v86, s[8:11], s68 offen offset:128 nt
  buffer_load_dwordx4 v[136:139], v86, s[8:11], s68 offen offset:512 nt
  buffer_load_dwordx4 v[140:143], v86, s[8:11], s68 offen offset:640 nt
  buffer_load_dwordx4 v[144:147], v87, s[8:11], s68 offen offset:0 nt
  buffer_load_dwordx4 v[148:151], v87, s[8:11], s68 offen offset:128 nt
  buffer_load_dwordx4 v[152:155], v87, s[8:11], s68 offen offset:512 nt
  buffer_load_dwordx4 v[156:159], v87, s[8:11], s68 offen offset:640 nt
  buffer_load_dwordx4 v[160:163], v86, s[8:11], s69 offen offset:0 nt
  buffer_load_dwordx4 v[164:167], v86, s[8:11], s69 offen offset:128 nt
  buffer_load_dwordx4 v[168:171], v86, s[8:11], s69 offen offset:512 nt
  buffer_load_dwordx4 v[172:175], v86, s[8:11], s69 offen offset:640 nt
  buffer_load_dwordx4 v[176:179], v87, s[8:11], s69 offen offset:0 nt
  buffer_load_dwordx4 v[180:183], v87, s[8:11], s69 offen offset:128 nt
  buffer_load_dwordx4 v[184:187], v87, s[8:11], s69 offen offset:512 nt
  buffer_load_dwordx4 v[188:191], v87, s[8:11], s69 offen offset:640 nt
  buffer_load_dwordx4 v[192:195], v86, s[8:11], s70 offen offset:0 nt
  buffer_load_dwordx4 v[196:199], v86, s[8:11], s70 offen offset:128 nt
  buffer_load_dwordx4 v[200:203], v86, s[8:11], s70 offen offset:512 nt
  buffer_load_dwordx4 v[204:207], v86, s[8:11], s70 offen offset:640 nt
  buffer_load_dwordx4 v[208:211], v87, s[8:11], s70 offen offset:0 nt
  buffer_load_dwordx4 v[212:215], v87, s[8:11], s70 offen offset:128 nt
  buffer_load_dwordx4 v[216:219], v87, s[8:11], s70 offen offset:512 nt
  buffer_load_dwordx4 v[220:223], v87, s[8:11], s70 offen offset:640 nt
  s_cmp_eq_u32 s3, 1
  s_cbranch_scc1 L_role2
  s_branch L_waitq
L_role:
  s_barrier
L_role2:
  s_mov_b32 s68, 28672
  v_lshrrev_b32 v80, 3, v0
  v_and_b32 v81, 7, v0
  v_lshlrev_b32 v81, 4, v81
L_r_not1:
  s_sub_u32 s67, s2, 112
  s_cmp_ge_u32 s67, 28
  s_cbranch_scc1 L_r_not2
  s_mov_b32 s20, s44
  s_mov_b32 s21, s45
  s_mov_b32 s22, 1835008
  s_mov_b32 s23, 0x20000
  s_mov_b32 s4, s32
  s_mov_b32 s5, s33
  s_mov_b32 s6, 2048
  s_mov_b32 s7, 0x20000
  v_mul_u32_u24 v82, 3584, v80
  v_add_u32 v82, v82, v81
  s_sub_u32 s67, s2, 112
  s_lshl_b32 s69, s67, 7
  s_lshl_b32 s69, s67, 7
  s_mov_b32 m0, 10240
  s_nop 0
  buffer_load_dwordx4 v3, s[4:7], 0 offen lds
  buffer_load_dwordx4 v3, s[4:7], 0 offen offset:1024 lds
  s_mov_b32 s78, 4000000
lw_1:
  ds_read_b32 v80, v5 offset:1024
  s_waitcnt lgkmcnt(0)
  v_cmp_ne_u32 vcc, 0, v80
  s_cbranch_vccnz lwd_2
  s_sub_u32 s78, s78, 1
  s_cmp_lg_u32 s78, 0
  s_sleep 2
  s_cbranch_scc1 lw_1
lwd_2:
  ds_read_b32 v80, v5 offset:1028
  s_waitcnt lgkmcnt(0)
  v_readfirstlane_b32 s60, v80
  v_lshlrev_b32 v84, 8, v0
  s_mov_b32 s67, 32768
  s_mov_b32 s78, 400000
poll_3:
  buffer_load_dwordx2 v[82:83], v84, s[16:19], s67 offen sc1
  s_waitcnt vmcnt(0)
  v_cmp_ne_u32 vcc, s60, v83
  s_cbranch_vccz pdone_4
  s_sub_u32 s78, s78, 1
  s_cmp_lg_u32 s78, 0
  s_sleep 1
  s_cbranch_scc1 poll_3
pdone_4:
  s_mov_b32 s67, 12288
  s_mov_b32 s68, 16384
  s_mov_b32 s69, 20480
  s_mov_b32 s78, 400000
poll_5:
  buffer_load_dwordx4 v[24:27], v3, s[16:19], s67 offen offset:0 sc1
  buffer_load_dwordx4 v[28:31], v3, s[16:19], s67 offen offset:1024 sc1
  buffer_load_dwordx4 v[32:35], v3, s[16:19], s67 offen offset:2048 sc1
  buffer_load_dwordx4 v[36:39], v3, s[16:19], s67 offen offset:3072 sc1
  buffer_load_dwordx4 v[40:43], v3, s[16:19], s68 offen offset:0 sc1
  buffer_load_dwordx4 v[44:47], v3, s[16:19], s68 offen offset:1024 sc1
  buffer_load_dwordx4 v[48:51], v3, s[16:19], s68 offen offset:2048 sc1
  buffer_load_dwordx4 v[52:55], v3, s[16:19], s68 offen offset:3072 sc1
  buffer_load_dwordx4 v[56:59], v3, s[16:19], s69 offen offset:0 sc1
  buffer_load_dwordx4 v[60:63], v3, s[16:19], s69 offen offset:1024 sc1
  buffer_load_dwordx4 v[64:67], v3, s[16:19], s69 offen offset:2048 sc1
  buffer_load_dwordx4 v[68:71], v3, s[16:19], s69 offen offset:3072 sc1
  s_waitcnt vmcnt(0)
  v_min3_u32 v80, v25, v27, v29
  v_max3_u32 v81, v25, v27, v29
  v_min3_u32 v80, v80, v31, v33
  v_max3_u32 v81, v81, v31, v33
  v_min3_u32 v80, v80, v35, v37
  v_max3_u32 v81, v81, v35, v37
  v_min3_u32 v80, v80, v39, v41
  v_max3_u32 v81, v81, v39, v41
  v_min3_u32 v80, v80, v43, v45
  v_max3_u32 v81, v81, v43, v45
  v_min3_u32 v80, v80, v47, v49
  v_max3_u32 v81, v81, v47, v49
  v_min3_u32 v80, v80, v51, v53
  v_max3_u32 v81, v81, v51, v53
  v_min3_u32 v80, v80, v55, v57
  v_max3_u32 v81, v81, v55, v57
  v_min3_u32 v80, v80, v59, v61
  v_max3_u32 v81, v81, v59, v61
  v_min3_u32 v80, v80, v63, v65
  v_max3_u32 v81, v81, v63, v65
  v_min3_u32 v80, v80, v67, v69
  v_max3_u32 v81, v81, v67, v69
  v_min3_u32 v80, v80, v71, v71
  v_max3_u32 v81, v81, v71, v71
  v_xor_b32 v80, s60, v80
  v_xor_b32 v81, s60, v81
  v_or_b32 v80, v80, v81
  v_cmp_ne_u32 vcc, 0, v80
  s_cbranch_vccz pdone_6
  s_sub_u32 s78, s78, 1
  s_cmp_lg_u32 s78, 0
  s_sleep 1
  s_cbranch_scc1 poll_5
pdone_6:
  v_lshlrev_b32 v80, 3, v0
  v_add_u32 v80, 4096, v80
  ds_write2_b32 v80, v24, v26 offset0:0 offset1:1
  ds_write2_b32 v80, v28, v30 offset0:128 offset1:129
  v_add_u32 v80, 1024, v80
  ds_write2_b32 v80, v32, v34 offset0:0 offset1:1
  ds_write2_b32 v80, v36, v38 offset0:128 offset1:129
  v_add_u32 v80, 1024, v80
  ds_write2_b32 v80, v40, v42 offset0:0 offset1:1
  ds_write2_b32 v80, v44, v46 offset0:128 offset1:129
  v_add_u32 v80, 1024, v80
  ds_write2_b32 v80, v48, v50 offset0:0 offset1:1
  ds_write2_b32 v80, v52, v54 offset0:128 offset1:129
  v_add_u32 v80, 1024, v80
  ds_write2_b32 v80, v56, v58 offset0:0 offset1:1
  ds_write2_b32 v80, v60, v62 offset0:128 offset1:129
  v_add_u32 v80, 1024, v80
  ds_write2_b32 v80, v64, v66 offset0:0 offset1:1
  ds_write2_b32 v80, v68, v70 offset0:128 offset1:129
  v_add_u32 v80, 1024, v80
  s_branch L_r_done
L_r_not2:
  s_cmp_lg_u32 s62, 9
  s_cbranch_scc1 L_r_done
  s_mov_b32 s78, 4000000
lw_7:
  ds_read_b32 v80, v5 offset:1024
  s_waitcnt lgkmcnt(0)
  v_cmp_ne_u32 vcc, 0, v80
  s_cbranch_vccnz lwd_8
  s_sub_u32 s78, s78, 1
  s_cmp_lg_u32 s78, 0
  s_sleep 2
  s_cbranch_scc1 lw_7
lwd_8:
  ds_read_b32 v80, v5 offset:1028
  s_waitcnt lgkmcnt(0)
  v_readfirstlane_b32 s60, v80
  v_lshlrev_b32 v84, 8, v0
  s_mov_b32 s67, 32768
  s_mov_b32 s78, 400000
poll_9:
  buffer_load_dwordx2 v[82:83], v84, s[16:19], s67 offen sc1
  s_waitcnt vmcnt(0)
  v_cmp_ne_u32 vcc, s60, v83
  s_cbranch_vccz pdone_10
  s_sub_u32 s78, s78, 1
  s_cmp_lg_u32 s78, 0
  s_sleep 1
  s_cbranch_scc1 poll_9
pdone_10:
L_r_done:
  s_waitcnt vmcnt(0) lgkmcnt(0)
  s_branch L_waitq
L_p1wg:
  v_lshlrev_b32 v3, 4, v0
  s_sub_u32 s4, s2, 16
  s_cmp_ge_u32 s4, 16
  s_cbranch_scc1 npf_11
  s_mov_b32 s26, CODE_LEN
  s_mov_b32 s27, 0x20000
  s_mul_i32 s4, s3, 3072
  buffer_load_dwordx4 v[200:203], v3, s[24:27], s4 offen offset:0
  buffer_load_dwordx4 v[200:203], v3, s[24:27], s4 offen offset:1024
  buffer_load_dwordx4 v[200:203], v3, s[24:27], s4 offen offset:2048
npf_11:
  s_lshl_b32 s76, s2, 6
  s_mov_b64 s[24:25], -1
  s_lshl_b32 s67, s3, 7
  v_lshlrev_b32 v7, 1, v0
  v_add_u32 v7, s67, v7
  v_lshrrev_b32 v40, 3, v0
  v_and_b32 v41, 7, v0
  v_lshlrev_b32 v41, 4, v41
  v_mul_u32_u24 v20, 6144, v40
  v_add_u32 v20, v20, v41
  s_mul_i32 s69, s3, 393216
  s_lshl_b32 s67, s76, 1
  s_add_u32 s69, s69, s67
  s_lshl_b32 s68, s3, 13
  s_add_u32 s68, s68, 28672
  s_mov_b32 s6, 2048
  s_mov_b32 s7, 0x20000
  s_mov_b32 s22, 3145728
  s_mov_b32 s23, 0x20000
  s_waitcnt lgkmcnt(0)
  s_mov_b64 s[4:5], s[50:51]
  s_mov_b64 s[20:21], s[52:53]
  buffer_load_ushort v9, v7, s[4:7], 0 offen
  buffer_load_ushort v10, v7, s[4:7], 0 offen offset:1024
  s_mov_b32 s70, 8
dma_12:
  s_mov_b32 m0, s68
  s_add_u32 s68, s68, 1024
  buffer_load_dwordx4 v20, s[20:23], s69 offen nt lds
  s_add_u32 s69, s69, 49152
  s_sub_u32 s70, s70, 1
  s_cmp_lg_u32 s70, 0
  s_cbranch_scc1 dma_12
  s_add_u32 s16, s58, 0x1fbfffff
  s_addc_u32 s17, s59, 0
  s_and_b32 s16, s16, 0xffe00000
  s_mov_b32 s18, 851968
  s_mov_b32 s19, 0x20000
  buffer_load_dword v8, off, s[16:19], 0 sc1
  s_bfe_u32 s63, s2, 0x10003
  s_and_b32 s64, s2, 7
  s_mov_b32 s71, 0x05040100
  s_mov_b32 s72, 0x07060302
  s_mov_b32 s73, 0x3fb8aa3b
  s_mov_b32 s74, 0x3db504f3
  s_mov_b32 s79, 0xffff0000
  s_lshl_b32 s65, s61, 12
  s_add_u32 s65, s65, 65536
  s_lshl_b32 s67, s61, 23
  v_mov_b32 v5, 0
  v_and_b32 v78, 3, v0
  v_lshlrev_b32 v78, 2, v78
  v_bfe_u32 v79, v0, 2, 1
  v_add_u32 v78, v78, v79
  v_lshlrev_b32 v78, 8, v78
  v_lshrrev_b32 v79, 3, v0
  v_lshl_add_u32 v86, v79, 4, v78
  v_add_u32 v87, 4096, v86
  v_and_b32 v78, 3, v0
  v_lshlrev_b32 v78, 2, v78
  v_bfe_u32 v79, v0, 2, 2
  v_add_u32 v78, v78, v79
  v_lshlrev_b32 v78, 8, v78
  v_lshrrev_b32 v79, 4, v0
  v_lshl_add_u32 v1, v79, 4, v78
  v_add_u32 v2, 4096, v1
  v_lshlrev_b32 v3, 4, v0
  v_add_u32 v4, 4096, v3
  s_mov_b32 s29, 245824
  s_cmp_eq_u32 s62, 0
  s_cselect_b32 s29, 60, s29
  s_cmp_eq_u32 s62, 1
  s_cselect_b32 s29, 16442, s29
  s_cmp_eq_u32 s62, 2
  s_cselect_b32 s29, 32826, s29
  s_cmp_eq_u32 s62, 3
  s_cselect_b32 s29, 49208, s29
  s_cmp_eq_u32 s62, 4
  s_cselect_b32 s29, 65592, s29
  s_cmp_eq_u32 s62, 5
  s_cselect_b32 s29, 81976, s29
  s_cmp_eq_u32 s62, 6
  s_cselect_b32 s29, 98358, s29
  s_cmp_eq_u32 s62, 7
  s_cselect_b32 s29, 114744, s29
  s_cmp_eq_u32 s62, 8
  s_cselect_b32 s29, 131130, s29
  s_cmp_eq_u32 s62, 9
  s_cselect_b32 s29, 147520, s29
  s_cmp_eq_u32 s62, 10
  s_cselect_b32 s29, 163904, s29
  s_cmp_eq_u32 s62, 11
  s_cselect_b32 s29, 180288, s29
  s_cmp_eq_u32 s62, 12
  s_cselect_b32 s29, 196672, s29
  s_cmp_eq_u32 s62, 13
  s_cselect_b32 s29, 213056, s29
  s_cmp_eq_u32 s62, 14
  s_cselect_b32 s29, 229440, s29
  s_and_b32 s28, s29, 255
  s_lshr_b32 s29, s29, 8
  s_lshr_b32 s28, s28, 1
  s_mov_b64 s[100:101], -1
  s_add_u32 s8, s34, s67
  s_addc_u32 s9, s35, 0
  s_mov_b32 s10, 8388608
  s_mov_b32 s11, 0x20000
  s_add_u32 s12, s36, s67
  s_addc_u32 s13, s37, 0
  s_mov_b32 s14, 8388608
  s_mov_b32 s15, 0x20000
  s_cmp_lg_u32 s3, 0
  s_cbranch_scc1 noinit_13
  v_mov_b32 v44, 0
  v_mov_b32 v45, 0
  v_mov_b32 v46, 21
  v_mov_b32 v47, 0
  ds_write_b128 v5, v[44:47] offset:1024
  v_mov_b32 v46, 0
  ds_write_b128 v5, v[44:47] offset:1040
noinit_13:
  v_lshrrev_b32 v40, 4, v0
  v_bfe_u32 v41, v0, 2, 2
  v_and_b32 v42, 3, v0
  v_lshl_add_u32 v41, v40, 3, v41
  s_lshl_b32 s67, s3, 6
  v_add_u32 v41, s67, v41
  v_lshlrev_b32 v42, 3, v42
  v_lshl_add_u32 v21, v41, 7, v42
  v_add_u32 v21, 28672, v21
  v_and_b32 v41, 1, v0
  v_mul_u32_u24 v22, 1088, v41
  v_lshl_add_u32 v22, v40, 4, v22
  s_lshl_b32 s67, s3, 7
  v_add_u32 v22, s67, v22
  s_lshl_b32 s67, s3, 9
  s_add_u32 s67, s67, 159744
  v_lshlrev_b32 v23, 3, v0
  v_add_u32 v23, s67, v23
  s_waitcnt vmcnt(9)
  v_lshlrev_b32 v9, 16, v9
  v_lshlrev_b32 v10, 16, v10
  v_mul_f32 v40, s73, v9
  v_mul_f32 v41, s73, v10
  v_exp_f32 v40, -v40
  v_exp_f32 v41, -v41
  v_add_f32 v40, 1.0, v40
  v_add_f32 v41, 1.0, v41
  v_rcp_f32 v42, v40
  v_rcp_f32 v43, v41
  v_mul_f32 v44, v9, v42
  v_mul_f32 v45, v10, v43
  v_min_f32 v40, 0x7f000000, v40
  v_min_f32 v41, 0x7f000000, v41
  v_fma_f32 v40, -v44, v40, v9
  v_fma_f32 v41, -v45, v41, v10
  v_fma_f32 v44, v40, v42, v44
  v_fma_f32 v45, v41, v43, v45
  v_cvt_pk_bf16_f32 v40, v44, v45
  ds_write_b16 v7, v40 offset:1536
  ds_write_b16_d16_hi v7, v40 offset:2624
  s_waitcnt lgkmcnt(0)
  ds_read_b128 v[44:47], v22 offset:1536
  ds_read_b128 v[48:51], v22 offset:1600
  s_waitcnt vmcnt(1)
  ds_read_b64_tr_b16 v[96:97], v21 offset:0
  ds_read_b64_tr_b16 v[98:99], v21 offset:512
  ds_read_b64_tr_b16 v[100:101], v21 offset:32
  ds_read_b64_tr_b16 v[102:103], v21 offset:544
  ds_read_b64_tr_b16 v[104:105], v21 offset:64
  ds_read_b64_tr_b16 v[106:107], v21 offset:576
  ds_read_b64_tr_b16 v[108:109], v21 offset:96
  ds_read_b64_tr_b16 v[110:111], v21 offset:608
  ds_read_b64_tr_b16 v[112:113], v21 offset:4096
  ds_read_b64_tr_b16 v[114:115], v21 offset:4608
  ds_read_b64_tr_b16 v[116:117], v21 offset:4128
  ds_read_b64_tr_b16 v[118:119], v21 offset:4640
  ds_read_b64_tr_b16 v[120:121], v21 offset:4160
  ds_read_b64_tr_b16 v[122:123], v21 offset:4672
  ds_read_b64_tr_b16 v[124:125], v21 offset:4192
  ds_read_b64_tr_b16 v[126:127], v21 offset:4704
  s_waitcnt lgkmcnt(0)
  v_mfma_f32_16x16x32_bf16 v[64:67], v[44:47], v[96:99], 0
  v_mfma_f32_16x16x32_bf16 v[68:71], v[44:47], v[100:103], 0
  v_mfma_f32_16x16x32_bf16 v[72:75], v[44:47], v[104:107], 0
  v_mfma_f32_16x16x32_bf16 v[76:79], v[44:47], v[108:111], 0
  v_mfma_f32_16x16x32_bf16 v[64:67], v[48:51], v[112:115], v[64:67]
  v_mfma_f32_16x16x32_bf16 v[68:71], v[48:51], v[116:119], v[68:71]
  v_mfma_f32_16x16x32_bf16 v[72:75], v[48:51], v[120:123], v[72:75]
  v_mfma_f32_16x16x32_bf16 v[76:79], v[48:51], v[124:127], v[76:79]
  s_mov_b64 exec, 0xffff
  s_nop 3
  ds_write_b64 v23, v[64:65] offset:0
  ds_write_b64 v23, v[68:69] offset:128
  ds_write_b64 v23, v[72:73] offset:256
  ds_write_b64 v23, v[76:77] offset:384
  s_mov_b64 exec, -1
  s_waitcnt vmcnt(0) lgkmcnt(0)
  s_barrier
  s_cmp_eq_u32 s3, 0
  s_cbranch_scc1 p1w0_14
  s_barrier
  s_mov_b32 s66, 1
  s_cmp_ge_u32 s3, 1
  s_cbranch_scc1 L_pref
  s_branch L_role2
p1w0_14:
  s_mov_b32 s66, 0
  ds_read_b64 v[176:177], v23 offset:0
  ds_read_b64 v[178:179], v23 offset:512
  ds_read_b64 v[180:181], v23 offset:1024
  ds_read_b64 v[182:183], v23 offset:1536
  ds_read_b64 v[184:185], v23 offset:2048
  ds_read_b64 v[186:187], v23 offset:2560
  ds_read_b64 v[188:189], v23 offset:3072
  ds_read_b64 v[190:191], v23 offset:3584
  v_readfirstlane_b32 s60, v8
  s_nop 0
  s_add_u32 s60, s60, 0x9e3779b9
  v_lshlrev_b32 v40, 3, v0
  v_mov_b32 v43, s60
  s_lshl_b32 s67, s76, 3
  s_add_u32 s67, s67, 4096
  s_waitcnt lgkmcnt(0)
  v_pk_add_f32 v[176:177], v[176:177], v[178:179]
  v_pk_add_f32 v[180:181], v[180:181], v[182:183]
  v_pk_add_f32 v[184:185], v[184:185], v[186:187]
  v_pk_add_f32 v[188:189], v[188:189], v[190:191]
  v_pk_add_f32 v[176:177], v[176:177], v[180:181]
  v_pk_add_f32 v[184:185], v[184:185], v[188:189]
  v_pk_add_f32 v[176:177], v[176:177], v[184:185]
  v_cvt_pk_bf16_f32 v42, v176, v177
  s_mov_b64 exec, s[24:25]
  buffer_store_dwordx2 v[42:43], v40, s[16:19], s67 offen sc1
  s_mov_b64 exec, -1
  s_barrier
  s_branch L_qpoll2
L_p2wg:
  s_sub_u32 s76, s2, 48
  v_lshlrev_b32 v3, 4, v0
  s_lshl_b32 s67, s3, 7
  v_lshlrev_b32 v7, 1, v0
  v_add_u32 v7, s67, v7
  v_lshrrev_b32 v40, 3, v0
  v_and_b32 v41, 7, v0
  v_lshlrev_b32 v41, 4, v41
  v_lshl_add_u32 v20, v40, 13, v41
  s_lshl_b32 s69, s3, 19
  s_lshl_b32 s67, s76, 7
  s_add_u32 s69, s69, s67
  s_lshl_b32 s68, s3, 13
  s_add_u32 s68, s68, 28672
  s_mov_b32 s26, 2048
  s_mov_b32 s27, 0x20000
  s_mov_b32 s6, 4194304
  s_mov_b32 s7, 0x20000
  s_waitcnt lgkmcnt(0)
  s_mov_b64 s[24:25], s[32:33]
  s_mov_b64 s[4:5], s[38:39]
  s_add_u32 s16, s58, 0x1fbfffff
  s_addc_u32 s17, s59, 0
  s_and_b32 s16, s16, 0xffe00000
  s_mov_b32 s18, 851968
  s_mov_b32 s19, 0x20000
  buffer_load_dword v8, off, s[16:19], 0 sc1
  buffer_load_ushort v10, v7, s[24:27], 0 offen
  buffer_load_ushort v11, v7, s[24:27], 0 offen offset:1024
  buffer_load_dwordx4 v[12:15], v3, s[24:27], 0 offen
  buffer_load_dwordx4 v[16:19], v3, s[24:27], 0 offen offset:1024
  s_mov_b32 s70, 8
dma_15:
  s_mov_b32 m0, s68
  s_add_u32 s68, s68, 1024
  buffer_load_dwordx4 v20, s[4:7], s69 offen nt lds
  s_add_u32 s69, s69, 65536
  s_sub_u32 s70, s70, 1
  s_cmp_lg_u32 s70, 0
  s_cbranch_scc1 dma_15
  s_bfe_u32 s63, s2, 0x10003
  s_and_b32 s64, s2, 7
  s_mov_b32 s71, 0x05040100
  s_mov_b32 s72, 0x07060302
  s_mov_b32 s73, 0x3fb8aa3b
  s_mov_b32 s74, 0x3db504f3
  s_mov_b32 s79, 0xffff0000
  s_lshl_b32 s65, s61, 12
  s_add_u32 s65, s65, 65536
  s_lshl_b32 s67, s61, 23
  v_mov_b32 v5, 0
  v_and_b32 v78, 3, v0
  v_lshlrev_b32 v78, 2, v78
  v_bfe_u32 v79, v0, 2, 1
  v_add_u32 v78, v78, v79
  v_lshlrev_b32 v78, 8, v78
  v_lshrrev_b32 v79, 3, v0
  v_lshl_add_u32 v86, v79, 4, v78
  v_add_u32 v87, 4096, v86
  v_and_b32 v78, 3, v0
  v_lshlrev_b32 v78, 2, v78
  v_bfe_u32 v79, v0, 2, 2
  v_add_u32 v78, v78, v79
  v_lshlrev_b32 v78, 8, v78
  v_lshrrev_b32 v79, 4, v0
  v_lshl_add_u32 v1, v79, 4, v78
  v_add_u32 v2, 4096, v1
  v_lshlrev_b32 v3, 4, v0
  v_add_u32 v4, 4096, v3
  s_mov_b32 s29, 245824
  s_cmp_eq_u32 s62, 0
  s_cselect_b32 s29, 60, s29
  s_cmp_eq_u32 s62, 1
  s_cselect_b32 s29, 16442, s29
  s_cmp_eq_u32 s62, 2
  s_cselect_b32 s29, 32826, s29
  s_cmp_eq_u32 s62, 3
  s_cselect_b32 s29, 49208, s29
  s_cmp_eq_u32 s62, 4
  s_cselect_b32 s29, 65592, s29
  s_cmp_eq_u32 s62, 5
  s_cselect_b32 s29, 81976, s29
  s_cmp_eq_u32 s62, 6
  s_cselect_b32 s29, 98358, s29
  s_cmp_eq_u32 s62, 7
  s_cselect_b32 s29, 114744, s29
  s_cmp_eq_u32 s62, 8
  s_cselect_b32 s29, 131130, s29
  s_cmp_eq_u32 s62, 9
  s_cselect_b32 s29, 147520, s29
  s_cmp_eq_u32 s62, 10
  s_cselect_b32 s29, 163904, s29
  s_cmp_eq_u32 s62, 11
  s_cselect_b32 s29, 180288, s29
  s_cmp_eq_u32 s62, 12
  s_cselect_b32 s29, 196672, s29
  s_cmp_eq_u32 s62, 13
  s_cselect_b32 s29, 213056, s29
  s_cmp_eq_u32 s62, 14
  s_cselect_b32 s29, 229440, s29
  s_and_b32 s28, s29, 255
  s_lshr_b32 s29, s29, 8
  s_lshr_b32 s28, s28, 1
  s_mov_b64 s[100:101], -1
  s_add_u32 s8, s34, s67
  s_addc_u32 s9, s35, 0
  s_mov_b32 s10, 8388608
  s_mov_b32 s11, 0x20000
  s_add_u32 s12, s36, s67
  s_addc_u32 s13, s37, 0
  s_mov_b32 s14, 8388608
  s_mov_b32 s15, 0x20000
  s_lshr_b32 s27, s38, 7
  s_add_u32 s27, s27, s76
  s_and_b32 s27, s27, 7
  s_cmp_eq_u32 s27, 3
  s_cbranch_scc1 nwe_16
  s_mov_b32 s20, s40
  s_mov_b32 s21, s41
  s_mov_b32 s22, 4194304
  s_mov_b32 s23, 0x20000
  v_lshrrev_b32 v40, 3, v0
  v_and_b32 v41, 7, v0
  v_lshlrev_b32 v41, 4, v41
  v_lshl_add_u32 v20, v40, 10, v41
  s_lshl_b32 s67, s63, 2
  s_add_u32 s67, s67, s62
  s_sub_u32 s67, s67, 3
  s_lshl_b32 s67, s67, 7
  s_lshl_b32 s69, s64, 19
  s_add_u32 s69, s69, s67
  s_lshl_b32 s67, s3, 16
  s_add_u32 s69, s69, s67
  s_add_u32 s69, s69, 0
  s_lshl_b32 s68, s3, 13
  s_add_u32 s68, s68, 94208
  s_waitcnt vmcnt(4)
  s_mov_b32 s70, 6
dma_17:
  s_mov_b32 m0, s68
  s_add_u32 s68, s68, 1024
  buffer_load_dwordx4 v20, s[20:23], s69 offen nt lds
  s_add_u32 s69, s69, 8192
  s_sub_u32 s70, s70, 1
  s_cmp_lg_u32 s70, 0
  s_cbranch_scc1 dma_17
nwe_16:
  v_mov_b32 v44, -1
  v_mov_b32 v45, -1
  s_and_b32 s67, s76, 7
  s_lshl_b32 s67, s67, 3
  s_add_u32 s67, s67, s3
  s_lshr_b32 s68, s67, 5
  s_lshl_b32 s68, s68, 3
  s_lshr_b32 s70, s76, 3
  s_add_u32 s68, s68, s70
  s_and_b32 s67, s67, 31
  s_lshl_b32 s69, s68, 5
  s_add_u32 s69, s69, s67
  s_lshl_b32 s70, s69, 9
  s_add_u32 s70, s70, 131072
  v_lshlrev_b32 v40, 3, v0
  buffer_store_dwordx2 v[44:45], v40, s[16:19], s70 offen sc1
  s_lshl_b32 s4, s76, 9
  s_lshl_b32 s5, s3, 8
  s_add_u32 s4, s4, s5
  s_add_u32 s4, s4, 655360
  s_lshl_b32 s5, s76, 8
  s_lshl_b32 s6, s3, 7
  s_add_u32 s5, s5, s6
  s_add_u32 s5, s5, 687872
  s_cmp_ge_u32 s3, 2
  s_cselect_b32 s4, s5, s4
  s_and_b32 s5, s76, 7
  s_lshl_b32 s6, s5, 2
  s_add_u32 s6, s6, s3
  s_sub_u32 s6, s6, 4
  s_lshr_b32 s7, s6, 4
  s_lshl_b32 s7, s7, 7
  s_and_b32 s6, s6, 15
  s_add_u32 s6, s6, s7
  s_lshr_b32 s7, s76, 3
  s_lshl_b32 s70, s7, 4
  s_add_u32 s6, s6, s70
  s_lshl_b32 s6, s6, 7
  s_add_u32 s6, s6, 720896
  s_cmp_ge_u32 s3, 4
  s_cselect_b32 s4, s6, s4
  v_add_u32 v41, s4, v3
  s_lshl_b32 s6, s5, 3
  s_add_u32 s6, s6, s7
  s_lshl_b32 s6, s6, 12
  s_add_u32 s6, s6, 65408
  v_add_u32 v42, s6, v3
  s_cmp_lt_u32 s3, 2
  s_cselect_b32 s6, 0xff00, 0
  s_or_b32 s6, s6, 0xff
  s_lshl_b32 s7, s5, 3
  s_add_u32 s7, s7, s3
  s_and_b32 s7, s7, 0x37
  s_cmp_eq_u32 s7, 4
  s_cselect_b32 s7, 0xff00, 0
  s_or_b32 s6, s6, s7
  v_mov_b32 v48, -1
  v_mov_b32 v49, -1
  v_mov_b32 v50, -1
  v_mov_b32 v51, -1
  s_mov_b32 exec_lo, s7
  s_mov_b32 exec_hi, 0
  v_mov_b32 v41, v42
  v_mov_b32 v48, 0
  v_mov_b32 v49, 0
  v_mov_b32 v50, 0
  v_mov_b32 v51, 0
  s_mov_b32 exec_lo, s6
  buffer_store_dwordx4 v[48:51], v41, s[16:19], 0 offen sc1
  s_mov_b64 exec, -1
  v_lshlrev_b32 v9, 2, v7
  s_mov_b32 s67, 4096
  s_mov_b32 s68, 8192
  buffer_load_dwordx2 v[60:61], v9, s[16:19], s67 offen sc1
  buffer_load_dwordx2 v[62:63], v9, s[16:19], s68 offen sc1
  s_cmp_lg_u32 s3, 0
  s_cbranch_scc1 noinit_18
  v_mov_b32 v40, 21
  ds_write_b32 v5, v5 offset:1024
  ds_write_b32 v5, v40 offset:1032
  ds_write_b32 v5, v5 offset:1036
noinit_18:
  v_lshrrev_b32 v40, 4, v0
  v_bfe_u32 v41, v0, 2, 2
  v_and_b32 v42, 3, v0
  v_lshl_add_u32 v41, v40, 3, v41
  s_lshl_b32 s67, s3, 6
  v_add_u32 v41, s67, v41
  v_lshlrev_b32 v42, 3, v42
  v_lshl_add_u32 v21, v41, 7, v42
  v_add_u32 v21, 28672, v21
  v_and_b32 v41, 1, v0
  v_mul_u32_u24 v22, 1088, v41
  v_lshl_add_u32 v22, v40, 4, v22
  s_lshl_b32 s67, s3, 7
  v_add_u32 v22, s67, v22
  s_lshl_b32 s67, s3, 9
  s_add_u32 s67, s67, 159744
  v_lshlrev_b32 v23, 3, v0
  v_add_u32 v23, s67, v23
  s_waitcnt vmcnt(16)
  s_cmp_lg_u32 s27, 3
  s_cbranch_scc1 pw_19
  s_waitcnt vmcnt(10)
pw_19:
  v_lshlrev_b32 v176, 16, v12
  v_and_b32 v177, s79, v12
  v_lshlrev_b32 v178, 16, v13
  v_and_b32 v179, s79, v13
  v_lshlrev_b32 v180, 16, v14
  v_and_b32 v181, s79, v14
  v_lshlrev_b32 v182, 16, v15
  v_and_b32 v183, s79, v15
  v_lshlrev_b32 v184, 16, v16
  v_and_b32 v185, s79, v16
  v_lshlrev_b32 v186, 16, v17
  v_and_b32 v187, s79, v17
  v_lshlrev_b32 v188, 16, v18
  v_and_b32 v189, s79, v18
  v_lshlrev_b32 v190, 16, v19
  v_and_b32 v191, s79, v19
  v_add_f32 v52, v176, v177
  v_add_f32 v52, v52, v178
  v_add_f32 v52, v52, v179
  v_add_f32 v52, v52, v180
  v_add_f32 v52, v52, v181
  v_add_f32 v52, v52, v182
  v_add_f32 v52, v52, v183
  v_add_f32 v53, v184, v185
  v_add_f32 v53, v53, v186
  v_add_f32 v53, v53, v187
  v_add_f32 v53, v53, v188
  v_add_f32 v53, v53, v189
  v_add_f32 v53, v53, v190
  v_add_f32 v53, v53, v191
  v_add_f32_dpp v52, v52, v52 quad_perm:[1,0,3,2] row_mask:0xf bank_mask:0xf
  s_nop 0
  v_add_f32_dpp v53, v53, v53 quad_perm:[1,0,3,2] row_mask:0xf bank_mask:0xf
  v_add_f32_dpp v52, v52, v52 quad_perm:[2,3,0,1] row_mask:0xf bank_mask:0xf
  s_nop 0
  v_add_f32_dpp v53, v53, v53 quad_perm:[2,3,0,1] row_mask:0xf bank_mask:0xf
  v_add_f32_dpp v52, v52, v52 row_half_mirror row_mask:0xf bank_mask:0xf
  s_nop 0
  v_add_f32_dpp v53, v53, v53 row_half_mirror row_mask:0xf bank_mask:0xf
  v_add_f32_dpp v52, v52, v52 row_mirror row_mask:0xf bank_mask:0xf
  s_nop 0
  v_add_f32_dpp v53, v53, v53 row_mirror row_mask:0xf bank_mask:0xf
  v_mov_b32 v40, v52
  v_mov_b32 v41, v53
  s_nop 0
  v_permlane16_swap_b32 v52, v40
  v_permlane16_swap_b32 v53, v41
  v_add_f32 v52, v52, v40
  v_add_f32 v53, v53, v41
  v_mov_b32 v40, v52
  v_mov_b32 v41, v53
  s_nop 0
  v_permlane32_swap_b32 v52, v40
  v_permlane32_swap_b32 v53, v41
  v_add_f32 v52, v52, v40
  v_add_f32 v53, v53, v41
  v_mul_f32 v52, 0x3b000000, v52
  v_mul_f32 v53, 0x3b000000, v53
  v_sub_f32 v40, v176, v52
  v_mul_f32 v54, v40, v40
  v_sub_f32 v40, v177, v52
  v_fmac_f32 v54, v40, v40
  v_sub_f32 v40, v178, v52
  v_fmac_f32 v54, v40, v40
  v_sub_f32 v40, v179, v52
  v_fmac_f32 v54, v40, v40
  v_sub_f32 v40, v180, v52
  v_fmac_f32 v54, v40, v40
  v_sub_f32 v40, v181, v52
  v_fmac_f32 v54, v40, v40
  v_sub_f32 v40, v182, v52
  v_fmac_f32 v54, v40, v40
  v_sub_f32 v40, v183, v52
  v_fmac_f32 v54, v40, v40
  v_sub_f32 v40, v184, v53
  v_mul_f32 v55, v40, v40
  v_sub_f32 v40, v185, v53
  v_fmac_f32 v55, v40, v40
  v_sub_f32 v40, v186, v53
  v_fmac_f32 v55, v40, v40
  v_sub_f32 v40, v187, v53
  v_fmac_f32 v55, v40, v40
  v_sub_f32 v40, v188, v53
  v_fmac_f32 v55, v40, v40
  v_sub_f32 v40, v189, v53
  v_fmac_f32 v55, v40, v40
  v_sub_f32 v40, v190, v53
  v_fmac_f32 v55, v40, v40
  v_sub_f32 v40, v191, v53
  v_fmac_f32 v55, v40, v40
  v_add_f32_dpp v54, v54, v54 quad_perm:[1,0,3,2] row_mask:0xf bank_mask:0xf
  s_nop 0
  v_add_f32_dpp v55, v55, v55 quad_perm:[1,0,3,2] row_mask:0xf bank_mask:0xf
  v_add_f32_dpp v54, v54, v54 quad_perm:[2,3,0,1] row_mask:0xf bank_mask:0xf
  s_nop 0
  v_add_f32_dpp v55, v55, v55 quad_perm:[2,3,0,1] row_mask:0xf bank_mask:0xf
  v_add_f32_dpp v54, v54, v54 row_half_mirror row_mask:0xf bank_mask:0xf
  s_nop 0
  v_add_f32_dpp v55, v55, v55 row_half_mirror row_mask:0xf bank_mask:0xf
  v_add_f32_dpp v54, v54, v54 row_mirror row_mask:0xf bank_mask:0xf
  s_nop 0
  v_add_f32_dpp v55, v55, v55 row_mirror row_mask:0xf bank_mask:0xf
  v_mov_b32 v40, v54
  v_mov_b32 v41, v55
  s_nop 0
  v_permlane16_swap_b32 v54, v40
  v_permlane16_swap_b32 v55, v41
  v_add_f32 v54, v54, v40
  v_add_f32 v55, v55, v41
  v_mov_b32 v40, v54
  v_mov_b32 v41, v55
  s_nop 0
  v_permlane32_swap_b32 v54, v40
  v_permlane32_swap_b32 v55, v41
  v_add_f32 v54, v54, v40
  v_add_f32 v55, v55, v41
  v_mul_f32 v54, 0x3b000000, v54
  v_mul_f32 v55, 0x3b000000, v55
  v_cvt_pk_bf16_f32 v40, v52, v53
  v_lshlrev_b32 v52, 16, v40
  v_and_b32 v53, s79, v40
  v_cvt_pk_bf16_f32 v40, v54, v55
  v_lshlrev_b32 v54, 16, v40
  v_and_b32 v55, s79, v40
  v_add_f32 v54, 0x3727c5ac, v54
  v_add_f32 v55, 0x3727c5ac, v55
  v_cvt_pk_bf16_f32 v40, v54, v55
  v_lshlrev_b32 v54, 16, v40
  v_and_b32 v55, s79, v40
  v_sqrt_f32 v54, v54
  v_sqrt_f32 v55, v55
  s_nop 0
  v_cvt_pk_bf16_f32 v40, v54, v55
  v_lshlrev_b32 v54, 16, v40
  v_and_b32 v55, s79, v40
  v_rcp_f32 v56, v54
  v_rcp_f32 v57, v55
  v_lshlrev_b32 v40, 16, v10
  v_lshlrev_b32 v41, 16, v11
  v_sub_f32 v40, v40, v52
  v_sub_f32 v41, v41, v53
  v_cvt_pk_bf16_f32 v42, v40, v41
  v_lshlrev_b32 v40, 16, v42
  v_and_b32 v41, s79, v42
  v_mul_f32 v36, v40, v56
  v_mul_f32 v37, v41, v57
  v_fma_f32 v40, -v36, v54, v40
  v_fma_f32 v41, -v37, v55, v41
  v_fma_f32 v36, v40, v56, v36
  v_fma_f32 v37, v41, v57, v37
  v_cvt_pk_bf16_f32 v42, v36, v37
  v_lshlrev_b32 v36, 16, v42
  v_and_b32 v37, s79, v42
  s_waitcnt vmcnt(8)
  s_cmp_lg_u32 s27, 3
  s_cbranch_scc1 pw_20
  s_waitcnt vmcnt(2)
pw_20:
  v_readfirstlane_b32 s60, v8
  s_nop 0
  s_add_u32 s60, s60, 0x9e3779b9
  ds_read_b64_tr_b16 v[96:97], v21 offset:0
  ds_read_b64_tr_b16 v[98:99], v21 offset:512
  ds_read_b64_tr_b16 v[100:101], v21 offset:32
  ds_read_b64_tr_b16 v[102:103], v21 offset:544
  ds_read_b64_tr_b16 v[104:105], v21 offset:64
  ds_read_b64_tr_b16 v[106:107], v21 offset:576
  ds_read_b64_tr_b16 v[108:109], v21 offset:96
  ds_read_b64_tr_b16 v[110:111], v21 offset:608
  ds_read_b64_tr_b16 v[112:113], v21 offset:4096
  ds_read_b64_tr_b16 v[114:115], v21 offset:4608
  ds_read_b64_tr_b16 v[116:117], v21 offset:4128
  ds_read_b64_tr_b16 v[118:119], v21 offset:4640
  ds_read_b64_tr_b16 v[120:121], v21 offset:4160
  ds_read_b64_tr_b16 v[122:123], v21 offset:4672
  ds_read_b64_tr_b16 v[124:125], v21 offset:4192
  ds_read_b64_tr_b16 v[126:127], v21 offset:4704
  v_and_b32 v178, 31, v0
  v_lshrrev_b32 v179, 5, v0
  v_lshlrev_b32 v177, 4, v178
  v_lshl_add_u32 v177, v179, 2, v177
  v_add_u32 v177, 159744, v177
  v_lshlrev_b32 v178, 3, v178
  v_lshl_add_u32 v178, v179, 14, v178
  v_mov_b32 v181, s60
  s_lshl_b32 s69, s76, 8
  s_add_u32 s69, s69, 32768
  s_mov_b32 s67, 4096
  s_mov_b32 s68, 8192
  s_mov_b32 s78, 400000
poll_21:
  buffer_load_dwordx2 v[60:61], v9, s[16:19], s67 offen sc1
  buffer_load_dwordx2 v[62:63], v9, s[16:19], s68 offen sc1
  s_waitcnt vmcnt(0)
  v_xor_b32 v40, s60, v61
  v_xor_b32 v41, s60, v63
  v_or_b32 v40, v40, v41
  v_cmp_ne_u32 vcc, 0, v40
  s_cbranch_vccz pdone_22
  s_sub_u32 s78, s78, 1
  s_cmp_lg_u32 s78, 0
  s_sleep 1
  s_cbranch_scc1 poll_21
pdone_22:
  v_lshlrev_b32 v40, 16, v62
  v_and_b32 v41, s79, v62
  v_add_f32 v40, 1.0, v40
  v_add_f32 v41, 1.0, v41
  v_cvt_pk_bf16_f32 v42, v40, v41
  v_lshlrev_b32 v40, 16, v42
  v_and_b32 v41, s79, v42
  v_mul_f32 v40, v40, v36
  v_mul_f32 v41, v41, v37
  v_cvt_pk_bf16_f32 v42, v40, v41
  v_lshlrev_b32 v40, 16, v42
  v_and_b32 v41, s79, v42
  v_lshlrev_b32 v42, 16, v60
  v_and_b32 v43, s79, v60
  v_add_f32 v40, v40, v42
  v_add_f32 v41, v41, v43
  v_cvt_pk_bf16_f32 v40, v40, v41
  ds_write_b16 v7, v40 offset:1536
  ds_write_b16_d16_hi v7, v40 offset:2624
  s_waitcnt lgkmcnt(0)
  ds_read_b128 v[44:47], v22 offset:1536
  ds_read_b128 v[48:51], v22 offset:1600
  s_waitcnt lgkmcnt(0)
  v_mfma_f32_16x16x32_bf16 v[64:67], v[44:47], v[96:99], 0
  v_mfma_f32_16x16x32_bf16 v[68:71], v[44:47], v[100:103], 0
  v_mfma_f32_16x16x32_bf16 v[72:75], v[44:47], v[104:107], 0
  v_mfma_f32_16x16x32_bf16 v[76:79], v[44:47], v[108:111], 0
  v_mfma_f32_16x16x32_bf16 v[64:67], v[48:51], v[112:115], v[64:67]
  v_mfma_f32_16x16x32_bf16 v[68:71], v[48:51], v[116:119], v[68:71]
  v_mfma_f32_16x16x32_bf16 v[72:75], v[48:51], v[120:123], v[72:75]
  v_mfma_f32_16x16x32_bf16 v[76:79], v[48:51], v[124:127], v[76:79]
  s_mov_b64 exec, 0xffff
  s_nop 3
  ds_write_b64 v23, v[64:65] offset:0
  ds_write_b64 v23, v[68:69] offset:128
  ds_write_b64 v23, v[72:73] offset:256
  ds_write_b64 v23, v[76:77] offset:384
  s_mov_b64 exec, -1
  s_mov_b32 s66, 0
  s_waitcnt lgkmcnt(0)
  s_barrier
  s_cmp_eq_u32 s3, 0
  s_cbranch_scc1 p2w0_23
  s_barrier
  s_cmp_lg_u32 s27, 3
  s_cbranch_scc1 wl_24
  s_mov_b32 s20, s40
  s_mov_b32 s21, s41
  s_mov_b32 s22, 4194304
  s_mov_b32 s23, 0x20000
  v_lshrrev_b32 v40, 3, v0
  v_and_b32 v41, 7, v0
  v_lshlrev_b32 v41, 4, v41
  v_lshl_add_u32 v20, v40, 10, v41
  s_lshl_b32 s67, s63, 2
  s_add_u32 s67, s67, s62
  s_sub_u32 s67, s67, 3
  s_lshl_b32 s67, s67, 7
  s_lshl_b32 s69, s64, 19
  s_add_u32 s69, s69, s67
  s_lshl_b32 s67, s3, 16
  s_add_u32 s69, s69, s67
  s_add_u32 s69, s69, 0
  s_lshl_b32 s68, s3, 13
  s_add_u32 s68, s68, 94208
  s_mov_b32 s70, 6
dma_25:
  s_mov_b32 m0, s68
  s_add_u32 s68, s68, 1024
  buffer_load_dwordx4 v20, s[20:23], s69 offen nt lds
  s_add_u32 s69, s69, 8192
  s_sub_u32 s70, s70, 1
  s_cmp_lg_u32 s70, 0
  s_cbranch_scc1 dma_25
wl_24:
  s_mov_b32 s20, s40
  s_mov_b32 s21, s41
  s_mov_b32 s22, 4194304
  s_mov_b32 s23, 0x20000
  v_lshrrev_b32 v40, 3, v0
  v_and_b32 v41, 7, v0
  v_lshlrev_b32 v41, 4, v41
  v_lshl_add_u32 v20, v40, 10, v41
  s_lshl_b32 s67, s63, 2
  s_add_u32 s67, s67, s62
  s_sub_u32 s67, s67, 3
  s_lshl_b32 s67, s67, 7
  s_lshl_b32 s69, s64, 19
  s_add_u32 s69, s69, s67
  s_lshl_b32 s67, s3, 16
  s_add_u32 s69, s69, s67
  s_add_u32 s69, s69, 49152
  s_lshl_b32 s68, s3, 13
  s_add_u32 s68, s68, 100352
  s_mov_b32 s70, 2
dma_26:
  s_mov_b32 m0, s68
  s_add_u32 s68, s68, 1024
  buffer_load_dwordx4 v20, s[20:23], s69 offen nt lds
  s_add_u32 s69, s69, 8192
  s_sub_u32 s70, s70, 1
  s_cmp_lg_u32 s70, 0
  s_cbranch_scc1 dma_26
  s_cmp_lt_u32 s3, 1
  s_cbranch_scc1 L_waitq
  s_mov_b32 s66, 1
  s_branch L_pref
p2w0_23:
  ds_read2_b32 v[96:97], v177 offset0:0 offset1:2
  ds_read2_b32 v[98:99], v177 offset0:128 offset1:130
  v_add_u32 v177, 1024, v177
  ds_read2_b32 v[100:101], v177 offset0:0 offset1:2
  ds_read2_b32 v[102:103], v177 offset0:128 offset1:130
  v_add_u32 v177, 1024, v177
  ds_read2_b32 v[104:105], v177 offset0:0 offset1:2
  ds_read2_b32 v[106:107], v177 offset0:128 offset1:130
  v_add_u32 v177, 1024, v177
  ds_read2_b32 v[108:109], v177 offset0:0 offset1:2
  ds_read2_b32 v[110:111], v177 offset0:128 offset1:130
  s_waitcnt lgkmcnt(0)
  v_pk_add_f32 v[96:97], v[96:97], v[98:99]
  v_pk_add_f32 v[100:101], v[100:101], v[102:103]
  v_pk_add_f32 v[104:105], v[104:105], v[106:107]
  v_pk_add_f32 v[108:109], v[108:109], v[110:111]
  v_pk_add_f32 v[96:97], v[96:97], v[100:101]
  v_pk_add_f32 v[104:105], v[104:105], v[108:109]
  v_pk_add_f32 v[96:97], v[96:97], v[104:105]
  v_cvt_pk_bf16_f32 v180, v96, v97
  buffer_store_dwordx2 v[180:181], v178, s[16:19], s69 offen sc1
  s_barrier
  s_cmp_lg_u32 s27, 3
  s_cbranch_scc1 wl_27
  s_mov_b32 s20, s40
  s_mov_b32 s21, s41
  s_mov_b32 s22, 4194304
  s_mov_b32 s23, 0x20000
  v_lshrrev_b32 v40, 3, v0
  v_and_b32 v41, 7, v0
  v_lshlrev_b32 v41, 4, v41
  v_lshl_add_u32 v20, v40, 10, v41
  s_lshl_b32 s67, s63, 2
  s_add_u32 s67, s67, s62
  s_sub_u32 s67, s67, 3
  s_lshl_b32 s67, s67, 7
  s_lshl_b32 s69, s64, 19
  s_add_u32 s69, s69, s67
  s_lshl_b32 s67, s3, 16
  s_add_u32 s69, s69, s67
  s_add_u32 s69, s69, 0
  s_lshl_b32 s68, s3, 13
  s_add_u32 s68, s68, 94208
  s_mov_b32 s70, 6
dma_28:
  s_mov_b32 m0, s68
  s_add_u32 s68, s68, 1024
  buffer_load_dwordx4 v20, s[20:23], s69 offen nt lds
  s_add_u32 s69, s69, 8192
  s_sub_u32 s70, s70, 1
  s_cmp_lg_u32 s70, 0
  s_cbranch_scc1 dma_28
wl_27:
  s_mov_b32 s20, s40
  s_mov_b32 s21, s41
  s_mov_b32 s22, 4194304
  s_mov_b32 s23, 0x20000
  v_lshrrev_b32 v40, 3, v0
  v_and_b32 v41, 7, v0
  v_lshlrev_b32 v41, 4, v41
  v_lshl_add_u32 v20, v40, 10, v41
  s_lshl_b32 s67, s63, 2
  s_add_u32 s67, s67, s62
  s_sub_u32 s67, s67, 3
  s_lshl_b32 s67, s67, 7
  s_lshl_b32 s69, s64, 19
  s_add_u32 s69, s69, s67
  s_lshl_b32 s67, s3, 16
  s_add_u32 s69, s69, s67
  s_add_u32 s69, s69, 49152
  s_lshl_b32 s68, s3, 13
  s_add_u32 s68, s68, 100352
  s_mov_b32 s70, 2
dma_29:
  s_mov_b32 m0, s68
  s_add_u32 s68, s68, 1024
  buffer_load_dwordx4 v20, s[20:23], s69 offen nt lds
  s_add_u32 s69, s69, 8192
  s_sub_u32 s70, s70, 1
  s_cmp_lg_u32 s70, 0
  s_cbranch_scc1 dma_29
  s_branch L_qpoll2
L_qpoll:
  buffer_load_dword v40, off, s[16:19], 0 sc1
  s_cmp_lt_u32 s62, 8
  s_cbranch_scc1 nep_30
  s_sub_u32 s4, s62, 8
  s_lshl_b32 s4, s4, 1
  s_bfe_u32 s5, s2, 0x10003
  s_add_u32 s70, s4, s5
  s_and_b32 s69, s2, 7
  v_lshrrev_b32 v8, 3, v0
  v_and_b32 v9, 7, v0
  v_lshlrev_b32 v9, 4, v9
  v_lshl_add_u32 v10, v8, 13, v9
  v_mul_u32_u24 v11, 6144, v8
  v_add_u32 v11, v11, v9
  s_mov_b32 s20, s52
  s_mov_b32 s21, s53
  s_mov_b32 s22, 3145728
  s_mov_b32 s23, 0x20000
  s_and_b32 s4, s70, 1
  s_lshl_b32 s4, s4, 3
  s_add_u32 s4, s4, s69
  s_lshl_b32 s4, s4, 7
  s_lshr_b32 s5, s70, 1
  s_mul_i32 s5, s5, 393216
  s_add_u32 s4, s4, s5
  s_add_u32 s5, s4, 0
  buffer_load_dwordx4 v[96:99], v11, s[20:23], s5 offen nt
  s_add_u32 s5, s4, 49152
  buffer_load_dwordx4 v[96:99], v11, s[20:23], s5 offen nt
  s_add_u32 s5, s4, 98304
  buffer_load_dwordx4 v[96:99], v11, s[20:23], s5 offen nt
  s_add_u32 s5, s4, 147456
  buffer_load_dwordx4 v[96:99], v11, s[20:23], s5 offen nt
  s_add_u32 s5, s4, 196608
  buffer_load_dwordx4 v[96:99], v11, s[20:23], s5 offen nt
  s_add_u32 s5, s4, 245760
  buffer_load_dwordx4 v[96:99], v11, s[20:23], s5 offen nt
  s_add_u32 s5, s4, 294912
  buffer_load_dwordx4 v[96:99], v11, s[20:23], s5 offen nt
  s_add_u32 s5, s4, 344064
  buffer_load_dwordx4 v[96:99], v11, s[20:23], s5 offen nt
  s_mov_b32 s20, s38
  s_mov_b32 s21, s39
  s_mov_b32 s22, 4194304
  s_mov_b32 s23, 0x20000
  s_and_b32 s4, s70, 7
  s_lshl_b32 s4, s4, 3
  s_add_u32 s4, s4, s69
  s_lshl_b32 s4, s4, 7
  s_lshr_b32 s5, s70, 3
  s_lshl_b32 s5, s5, 20
  s_add_u32 s4, s4, s5
  s_add_u32 s5, s4, 2097152
  buffer_load_dwordx4 v[96:99], v10, s[20:23], s5 offen nt
  s_add_u32 s5, s4, 2162688
  buffer_load_dwordx4 v[96:99], v10, s[20:23], s5 offen nt
  s_add_u32 s5, s4, 2228224
  buffer_load_dwordx4 v[96:99], v10, s[20:23], s5 offen nt
  s_add_u32 s5, s4, 2293760
  buffer_load_dwordx4 v[96:99], v10, s[20:23], s5 offen nt
  s_add_u32 s5, s4, 2359296
  buffer_load_dwordx4 v[96:99], v10, s[20:23], s5 offen nt
  s_add_u32 s5, s4, 2424832
  buffer_load_dwordx4 v[96:99], v10, s[20:23], s5 offen nt
  s_add_u32 s5, s4, 2490368
  buffer_load_dwordx4 v[96:99], v10, s[20:23], s5 offen nt
  s_add_u32 s5, s4, 2555904
  buffer_load_dwordx4 v[96:99], v10, s[20:23], s5 offen nt
  s_add_u32 s5, s4, 2621440
  buffer_load_dwordx4 v[96:99], v10, s[20:23], s5 offen nt
  s_add_u32 s5, s4, 2686976
  buffer_load_dwordx4 v[96:99], v10, s[20:23], s5 offen nt
  s_add_u32 s5, s4, 2752512
  buffer_load_dwordx4 v[96:99], v10, s[20:23], s5 offen nt
  s_add_u32 s5, s4, 2818048
  buffer_load_dwordx4 v[96:99], v10, s[20:23], s5 offen nt
  s_add_u32 s5, s4, 2883584
  buffer_load_dwordx4 v[96:99], v10, s[20:23], s5 offen nt
  s_add_u32 s5, s4, 2949120
  buffer_load_dwordx4 v[96:99], v10, s[20:23], s5 offen nt
  s_add_u32 s5, s4, 3014656
  buffer_load_dwordx4 v[96:99], v10, s[20:23], s5 offen nt
  s_add_u32 s5, s4, 3080192
  buffer_load_dwordx4 v[96:99], v10, s[20:23], s5 offen nt
nep_30:
  v_mov_b32 v44, 0
  v_mov_b32 v45, 0
  v_mov_b32 v46, 21
  v_mov_b32 v47, 0
  ds_write_b128 v5, v[44:47] offset:1024
  v_mov_b32 v46, 0
  ds_write_b128 v5, v[44:47] offset:1040
  s_waitcnt lgkmcnt(0)
  s_barrier
  s_waitcnt vmcnt(0)
  v_readfirstlane_b32 s60, v40
  s_nop 0
  s_add_u32 s60, s60, 0x9e3779b9
  s_mov_b32 s66, 0
L_qpoll2:
  s_and_b32 s67, s61, 7
  s_lshl_b32 s67, s67, 11
  s_lshr_b32 s68, s61, 3
  s_lshl_b32 s68, s68, 14
  s_add_u32 s67, s67, s68
  s_add_u32 s67, s67, 32768
  v_lshlrev_b32 v48, 3, v0
  s_mov_b32 s78, 400000
poll_31:
  buffer_load_dwordx4 v[96:99], v3, s[16:19], s67 offen offset:0 sc1
  buffer_load_dwordx4 v[100:103], v3, s[16:19], s67 offen offset:1024 sc1
  s_waitcnt vmcnt(0)
  v_min3_u32 v40, v97, v99, v101
  v_max3_u32 v41, v97, v99, v101
  v_min3_u32 v40, v40, v103, v103
  v_max3_u32 v41, v41, v103, v103
  v_xor_b32 v40, s60, v40
  v_xor_b32 v41, s60, v41
  v_or_b32 v40, v40, v41
  v_cmp_ne_u32 vcc, 0, v40
  s_cbranch_vccz pdone_32
  s_sub_u32 s78, s78, 1
  s_cmp_lg_u32 s78, 0
  s_sleep 1
  s_cbranch_scc1 poll_31
pdone_32:
  ds_write2_b32 v48, v96, v98 offset0:0 offset1:1
  ds_write2_b32 v48, v100, v102 offset0:128 offset1:129
  v_lshlrev_b32 v40, 10, v0
  ds_write_b32 v40, v5 offset:29184
  v_mov_b32 v40, 1
  v_mov_b32 v41, s60
  s_waitcnt lgkmcnt(0)
  ds_write_b64 v5, v[40:41] offset:1024
  s_sub_u32 s67, s62, 3
  s_cmp_ge_u32 s67, 4
  s_cbranch_scc1 n64_33
  v_lshlrev_b32 v44, 8, v0
  s_mov_b32 s67, 32768
  s_mov_b32 s78, 400000
poll_34:
  buffer_load_dwordx2 v[42:43], v44, s[16:19], s67 offen sc1
  s_waitcnt vmcnt(0)
  v_cmp_ne_u32 vcc, s60, v43
  s_cbranch_vccz pdone_35
  s_sub_u32 s78, s78, 1
  s_cmp_lg_u32 s78, 0
  s_sleep 8
  s_cbranch_scc1 poll_34
pdone_35:
n64_33:
  s_mov_b32 s78, 400000
dw_36:
  ds_read_b32 v8, v5 offset:1032
  s_waitcnt lgkmcnt(0)
  v_readfirstlane_b32 s7, v8
  s_nop 0
  s_cmp_ge_u32 s7, 33
  s_cbranch_scc1 dwd_37
  s_sub_u32 s78, s78, 1
  s_cmp_lg_u32 s78, 0
  s_sleep 8
  s_cbranch_scc1 dw_36
dwd_37:
  v_mov_b32 v8, 0
  v_mov_b32 v9, 0
  v_mov_b32 v10, 0
  v_mov_b32 v11, 0
  v_mov_b32 v22, 0
  v_mov_b32 v40, 0
  v_mov_b32 v41, 0
  v_mov_b32 v42, 0
  v_mov_b32 v92, 0
  s_mov_b64 s[24:25], 0
  s_mov_b64 s[100:101], 0
  s_mov_b64 exec, 0
  s_branch L_dry0
L_dryret:
  s_waitcnt vmcnt(0) lgkmcnt(0)
  s_mov_b64 s[100:101], -1
  s_mov_b64 exec, -1
L_waitq:
  v_mov_b32 v24, 0
  v_mov_b32 v25, 0
  v_mov_b32 v26, 0
  v_mov_b32 v27, 0
  v_mov_b32 v28, 0
  v_mov_b32 v29, 0
  v_mov_b32 v30, 0
  v_mov_b32 v31, 0
  v_mov_b32 v32, 0
  v_mov_b32 v33, 0
  v_mov_b32 v34, 0
  v_mov_b32 v35, 0
  v_mov_b32 v36, 0
  v_mov_b32 v37, 0
  v_mov_b32 v38, 0
  v_mov_b32 v39, 0
  v_mov_b32 v40, 0
  v_mov_b32 v41, 0
  v_mov_b32 v42, 0
  v_mov_b32 v43, 0
  v_mov_b32 v44, 0
  v_mov_b32 v45, 0
  v_mov_b32 v46, 0
  v_mov_b32 v47, 0
  v_mov_b32 v48, 0
  v_mov_b32 v49, 0
  v_mov_b32 v50, 0
  v_mov_b32 v51, 0
  v_mov_b32 v52, 0
  v_mov_b32 v53, 0
  v_mov_b32 v54, 0
  v_mov_b32 v55, 0
  v_mov_b32 v76, 0xff7fffff
  v_mov_b32 v77, 0
  s_mov_b32 s31, 0
  v_and_b32 v78, 3, v0
  v_lshlrev_b32 v78, 8, v78
  v_lshrrev_b32 v79, 4, v0
  v_lshl_add_u32 v7, v79, 4, v78
  v_lshl_add_u32 v78, v79, 5, v78
  v_bfe_u32 v80, v0, 2, 1
  v_lshl_add_u32 v78, v80, 4, v78
  s_mov_b32 s75, 0
  s_mov_b32 s76, -1
  s_sub_u32 s67, s2, 112
  s_cmp_lt_u32 s67, 28
  s_cbranch_scc0 lm_38
  s_mov_b32 s76, 7897088
  s_sub_u32 s67, s67, 16
  s_cmp_lt_u32 s67, 12
  s_cselect_b32 s75, 1, 0
lm_38:
  s_cmp_eq_u32 s62, 9
  s_cselect_b32 s76, 8388608, s76
  v_and_b32 v80, 15, v0
  v_lshlrev_b32 v88, 5, v80
  s_lshl_b32 s67, s3, 2
  s_add_u32 s67, s67, 1024
  v_add_u32 v88, s67, v88
  v_lshlrev_b32 v89, 9, v80
  v_lshl_add_u32 v89, v79, 4, v89
  s_lshl_b32 s67, s3, 11
  v_add_u32 v89, s67, v89
  s_and_b32 s4, s3, 3
  s_lshl_b32 s67, s4, 5
  v_mov_b32 v90, s67
  s_lshl_b32 s67, s4, 9
  v_lshlrev_b32 v91, 3, v0
  v_add_u32 v91, s67, v91
  v_lshrrev_b32 v92, 1, v91
  s_lshl_b32 s68, s61, 4
  s_add_u32 s68, s68, s62
  s_lshl_b32 s24, s68, 10
  s_add_u32 s24, s24, 131072
  s_lshl_b32 s25, s68, 7
  s_add_u32 s25, s25, 720896
  s_lshl_b32 s67, s4, 2
  s_add_u32 s25, s25, s67
  s_cmp_lg_u32 s3, 4
  s_cbranch_scc1 n4_39
  v_and_b32 v93, 31, v0
  v_lshlrev_b32 v93, 2, v93
  v_add_u32 v93, 1280, v93
  v_and_b32 v92, 31, v0
  v_lshlrev_b32 v92, 2, v92
  v_lshrrev_b32 v81, 5, v0
  v_lshl_add_u32 v92, v81, 13, v92
n4_39:
  s_cmp_lg_u32 s3, 0
  s_cbranch_scc1 n0_40
  v_mov_b32 v81, 0xff7fffff
  s_mov_b64 exec, 0xf
  ds_write2_b32 v88, v81, v5 offset0:64 offset1:96
  s_mov_b64 exec, -1
n0_40:
  s_mov_b32 s78, 4000000
lw_41:
  ds_read_b32 v79, v5 offset:1024
  s_waitcnt lgkmcnt(0)
  v_cmp_ne_u32 vcc, 0, v79
  s_cbranch_vccnz lwd_42
  s_sub_u32 s78, s78, 1
  s_cmp_lg_u32 s78, 0
  s_sleep 2
  s_cbranch_scc1 lw_41
lwd_42:
  ds_read_b128 v[8:11], v7 offset:0
  ds_read_b128 v[12:15], v7 offset:64
  ds_read_b128 v[16:19], v7 offset:128
  ds_read_b128 v[20:23], v7 offset:192
  ds_read_b128 v[68:71], v78 offset:0
  ds_read_b128 v[72:75], v78 offset:128
  v_and_b32 v80, 3, v0
  v_lshlrev_b32 v95, 4, v80
  v_lshrrev_b32 v81, 4, v0
  v_lshl_add_u32 v95, v81, 6, v95
  v_add_u32 v95, 28672, v95
  ds_read_b32 v79, v5 offset:1028
  s_waitcnt lgkmcnt(0)
  v_readfirstlane_b32 s60, v79
  s_cmp_eq_u32 s66, 0
  s_cbranch_scc1 nfirst_43
  s_branch L_k1
nfirst_43:
  s_branch L_sdone
L_k1:
  v_mov_b32 v232, s74
  v_mov_b32 v233, s74
  s_add_u32 s30, s77, 14
  s_lshl_b32 s67, s30, 1
  s_add_u32 s67, s67, s29
  s_lshl_b32 s67, s67, 13
  s_add_u32 s70, s67, 8192
  s_lshl_b32 s69, s77, 10
  v_add_u32 v94, s69, v95
  s_waitcnt vmcnt(24)
  v_mfma_f32_16x16x32_bf16 v[56:59], v[96:99], v[68:71], 0
  v_mfma_f32_16x16x32_bf16 v[224:227], v[104:107], v[68:71], 0
  v_mfma_f32_16x16x32_bf16 v[60:63], v[112:115], v[68:71], 0
  v_mfma_f32_16x16x32_bf16 v[228:231], v[120:123], v[68:71], 0
  v_mfma_f32_16x16x32_bf16 v[56:59], v[100:103], v[72:75], v[56:59]
  v_mfma_f32_16x16x32_bf16 v[224:227], v[108:111], v[72:75], v[224:227]
  v_mfma_f32_16x16x32_bf16 v[60:63], v[116:119], v[72:75], v[60:63]
  v_mfma_f32_16x16x32_bf16 v[228:231], v[124:127], v[72:75], v[228:231]
  buffer_load_dwordx4 v[96:99], v86, s[8:11], s67 offen offset:0 nt
  buffer_load_dwordx4 v[100:103], v86, s[8:11], s67 offen offset:128 nt
  buffer_load_dwordx4 v[104:107], v86, s[8:11], s67 offen offset:512 nt
  buffer_load_dwordx4 v[108:111], v86, s[8:11], s67 offen offset:640 nt
  buffer_load_dwordx4 v[112:115], v87, s[8:11], s67 offen offset:0 nt
  buffer_load_dwordx4 v[116:119], v87, s[8:11], s67 offen offset:128 nt
  buffer_load_dwordx4 v[120:123], v87, s[8:11], s67 offen offset:512 nt
  buffer_load_dwordx4 v[124:127], v87, s[8:11], s67 offen offset:640 nt
  v_permlane32_swap_b32 v56, v224
  v_permlane32_swap_b32 v57, v225
  v_permlane32_swap_b32 v58, v226
  v_permlane32_swap_b32 v59, v227
  v_permlane32_swap_b32 v60, v228
  v_permlane32_swap_b32 v61, v229
  v_permlane32_swap_b32 v62, v230
  v_permlane32_swap_b32 v63, v231
  v_add_f32_dpp v56, v224, v56 row_ror:4 row_mask:0xf bank_mask:0xf
  v_add_f32_dpp v57, v225, v57 row_ror:4 row_mask:0xf bank_mask:0xf
  v_add_f32_dpp v58, v226, v58 row_ror:4 row_mask:0xf bank_mask:0xf
  v_add_f32_dpp v59, v227, v59 row_ror:4 row_mask:0xf bank_mask:0xf
  v_add_f32_dpp v60, v228, v60 row_ror:4 row_mask:0xf bank_mask:0xf
  v_add_f32_dpp v61, v229, v61 row_ror:4 row_mask:0xf bank_mask:0xf
  v_add_f32_dpp v62, v230, v62 row_ror:4 row_mask:0xf bank_mask:0xf
  v_add_f32_dpp v63, v231, v63 row_ror:4 row_mask:0xf bank_mask:0xf
  v_cvt_pk_bf16_f32 v78, v56, v57
  v_cvt_pk_bf16_f32 v79, v58, v59
  v_cvt_pk_bf16_f32 v80, v60, v61
  v_cvt_pk_bf16_f32 v81, v62, v63
  v_lshlrev_b32 v56, 16, v78
  v_and_b32 v57, s79, v78
  v_lshlrev_b32 v58, 16, v79
  v_and_b32 v59, s79, v79
  v_lshlrev_b32 v60, 16, v80
  v_and_b32 v61, s79, v80
  v_lshlrev_b32 v62, 16, v81
  v_and_b32 v63, s79, v81
  v_pk_mul_f32 v[56:57], v[56:57], v[232:233]
  v_pk_mul_f32 v[58:59], v[58:59], v[232:233]
  v_pk_mul_f32 v[60:61], v[60:61], v[232:233]
  v_pk_mul_f32 v[62:63], v[62:63], v[232:233]
  v_cvt_pk_bf16_f32 v64, v56, v57
  v_cvt_pk_bf16_f32 v65, v58, v59
  v_cvt_pk_bf16_f32 v66, v60, v61
  v_cvt_pk_bf16_f32 v67, v62, v63
  s_mov_b32 exec_lo, 0x000f000f
  s_mov_b32 exec_hi, 0x000f000f
  ds_write_b128 v94, v[64:67] offset:0
  s_mov_b64 exec, -1
  s_waitcnt vmcnt(24)
  v_mfma_f32_16x16x32_bf16 v[56:59], v[128:131], v[68:71], 0
  v_mfma_f32_16x16x32_bf16 v[224:227], v[136:139], v[68:71], 0
  v_mfma_f32_16x16x32_bf16 v[60:63], v[144:147], v[68:71], 0
  v_mfma_f32_16x16x32_bf16 v[228:231], v[152:155], v[68:71], 0
  v_mfma_f32_16x16x32_bf16 v[56:59], v[132:135], v[72:75], v[56:59]
  v_mfma_f32_16x16x32_bf16 v[224:227], v[140:143], v[72:75], v[224:227]
  v_mfma_f32_16x16x32_bf16 v[60:63], v[148:151], v[72:75], v[60:63]
  v_mfma_f32_16x16x32_bf16 v[228:231], v[156:159], v[72:75], v[228:231]
  buffer_load_dwordx4 v[128:131], v86, s[8:11], s70 offen offset:0 nt
  buffer_load_dwordx4 v[132:135], v86, s[8:11], s70 offen offset:128 nt
  buffer_load_dwordx4 v[136:139], v86, s[8:11], s70 offen offset:512 nt
  buffer_load_dwordx4 v[140:143], v86, s[8:11], s70 offen offset:640 nt
  buffer_load_dwordx4 v[144:147], v87, s[8:11], s70 offen offset:0 nt
  buffer_load_dwordx4 v[148:151], v87, s[8:11], s70 offen offset:128 nt
  buffer_load_dwordx4 v[152:155], v87, s[8:11], s70 offen offset:512 nt
  buffer_load_dwordx4 v[156:159], v87, s[8:11], s70 offen offset:640 nt
  v_permlane32_swap_b32 v56, v224
  v_permlane32_swap_b32 v57, v225
  v_permlane32_swap_b32 v58, v226
  v_permlane32_swap_b32 v59, v227
  v_permlane32_swap_b32 v60, v228
  v_permlane32_swap_b32 v61, v229
  v_permlane32_swap_b32 v62, v230
  v_permlane32_swap_b32 v63, v231
  v_add_f32_dpp v56, v224, v56 row_ror:4 row_mask:0xf bank_mask:0xf
  v_add_f32_dpp v57, v225, v57 row_ror:4 row_mask:0xf bank_mask:0xf
  v_add_f32_dpp v58, v226, v58 row_ror:4 row_mask:0xf bank_mask:0xf
  v_add_f32_dpp v59, v227, v59 row_ror:4 row_mask:0xf bank_mask:0xf
  v_add_f32_dpp v60, v228, v60 row_ror:4 row_mask:0xf bank_mask:0xf
  v_add_f32_dpp v61, v229, v61 row_ror:4 row_mask:0xf bank_mask:0xf
  v_add_f32_dpp v62, v230, v62 row_ror:4 row_mask:0xf bank_mask:0xf
  v_add_f32_dpp v63, v231, v63 row_ror:4 row_mask:0xf bank_mask:0xf
  v_cvt_pk_bf16_f32 v78, v56, v57
  v_cvt_pk_bf16_f32 v79, v58, v59
  v_cvt_pk_bf16_f32 v80, v60, v61
  v_cvt_pk_bf16_f32 v81, v62, v63
  v_lshlrev_b32 v56, 16, v78
  v_and_b32 v57, s79, v78
  v_lshlrev_b32 v58, 16, v79
  v_and_b32 v59, s79, v79
  v_lshlrev_b32 v60, 16, v80
  v_and_b32 v61, s79, v80
  v_lshlrev_b32 v62, 16, v81
  v_and_b32 v63, s79, v81
  v_pk_mul_f32 v[56:57], v[56:57], v[232:233]
  v_pk_mul_f32 v[58:59], v[58:59], v[232:233]
  v_pk_mul_f32 v[60:61], v[60:61], v[232:233]
  v_pk_mul_f32 v[62:63], v[62:63], v[232:233]
  v_cvt_pk_bf16_f32 v64, v56, v57
  v_cvt_pk_bf16_f32 v65, v58, v59
  v_cvt_pk_bf16_f32 v66, v60, v61
  v_cvt_pk_bf16_f32 v67, v62, v63
  s_mov_b32 exec_lo, 0x000f000f
  s_mov_b32 exec_hi, 0x000f000f
  ds_write_b128 v94, v[64:67] offset:256
  ds_write_b32 v94, v232 offset:512
  s_mov_b64 exec, -1
  s_add_u32 s77, s77, 7
  s_lshl_b32 s69, s77, 10
  v_add_u32 v94, s69, v95
  s_mov_b32 s30, 1024
  s_cmp_lt_u32 s3, 4
  s_cbranch_scc1 dd_45
  s_cmp_lg_u32 s31, 0
  s_cbranch_scc1 dg_44
  v_mov_b32 v6, 1
  s_mov_b64 exec, 1
  ds_add_rtn_u32 v6, v5, v6 offset:1032
  s_mov_b64 exec, -1
  s_waitcnt lgkmcnt(0)
  v_readfirstlane_b32 s68, v6
  s_nop 0
  s_mov_b32 s30, s68
  s_lshr_b32 s68, s68, 1
  s_cmp_lt_u32 s68, s28
  s_cbranch_scc1 dd_45
  s_mov_b32 s30, 1024
  s_cmp_lg_u32 s75, 0
  s_cbranch_scc1 dd_45
  s_mov_b32 s31, 1
dg_44:
  v_mov_b32 v6, 1
  s_mov_b64 exec, 1
  buffer_atomic_add v6, off, s[16:19], s65 sc0 sc1
  s_mov_b64 exec, -1
dd_45:
  s_waitcnt vmcnt(24)
  v_mfma_f32_16x16x32_bf16 v[56:59], v[160:163], v[68:71], 0
  v_mfma_f32_16x16x32_bf16 v[224:227], v[168:171], v[68:71], 0
  v_mfma_f32_16x16x32_bf16 v[60:63], v[176:179], v[68:71], 0
  v_mfma_f32_16x16x32_bf16 v[228:231], v[184:187], v[68:71], 0
  v_mfma_f32_16x16x32_bf16 v[56:59], v[164:167], v[72:75], v[56:59]
  v_mfma_f32_16x16x32_bf16 v[224:227], v[172:175], v[72:75], v[224:227]
  v_mfma_f32_16x16x32_bf16 v[60:63], v[180:183], v[72:75], v[60:63]
  v_mfma_f32_16x16x32_bf16 v[228:231], v[188:191], v[72:75], v[228:231]
  s_nop 5
  v_permlane32_swap_b32 v56, v224
  v_permlane32_swap_b32 v57, v225
  v_permlane32_swap_b32 v58, v226
  s_nop 2
  v_permlane32_swap_b32 v59, v227
  v_permlane32_swap_b32 v60, v228
  v_permlane32_swap_b32 v61, v229
  v_permlane32_swap_b32 v62, v230
  v_permlane32_swap_b32 v63, v231
  v_add_f32_dpp v56, v224, v56 row_ror:4 row_mask:0xf bank_mask:0xf
  v_add_f32_dpp v57, v225, v57 row_ror:4 row_mask:0xf bank_mask:0xf
  v_add_f32_dpp v58, v226, v58 row_ror:4 row_mask:0xf bank_mask:0xf
  v_add_f32_dpp v59, v227, v59 row_ror:4 row_mask:0xf bank_mask:0xf
  v_add_f32_dpp v60, v228, v60 row_ror:4 row_mask:0xf bank_mask:0xf
  v_add_f32_dpp v61, v229, v61 row_ror:4 row_mask:0xf bank_mask:0xf
  v_add_f32_dpp v62, v230, v62 row_ror:4 row_mask:0xf bank_mask:0xf
  v_add_f32_dpp v63, v231, v63 row_ror:4 row_mask:0xf bank_mask:0xf
  v_cvt_pk_bf16_f32 v78, v56, v57
  v_cvt_pk_bf16_f32 v79, v58, v59
  v_cvt_pk_bf16_f32 v80, v60, v61
  v_cvt_pk_bf16_f32 v81, v62, v63
  v_lshlrev_b32 v56, 16, v78
  v_and_b32 v57, s79, v78
  v_lshlrev_b32 v58, 16, v79
  v_and_b32 v59, s79, v79
  v_lshlrev_b32 v60, 16, v80
  v_and_b32 v61, s79, v80
  v_lshlrev_b32 v62, 16, v81
  v_and_b32 v63, s79, v81
  v_pk_mul_f32 v[56:57], v[56:57], v[232:233]
  v_pk_mul_f32 v[58:59], v[58:59], v[232:233]
  v_pk_mul_f32 v[60:61], v[60:61], v[232:233]
  v_pk_mul_f32 v[62:63], v[62:63], v[232:233]
  v_cvt_pk_bf16_f32 v64, v56, v57
  v_cvt_pk_bf16_f32 v65, v58, v59
  v_cvt_pk_bf16_f32 v66, v60, v61
  v_cvt_pk_bf16_f32 v67, v62, v63
  s_mov_b32 exec_lo, 0x000f000f
  s_mov_b32 exec_hi, 0x000f000f
  ds_write_b128 v94, v[64:67] offset:0
  s_mov_b64 exec, -1
  s_waitcnt vmcnt(16)
  v_mfma_f32_16x16x32_bf16 v[56:59], v[192:195], v[68:71], 0
  v_mfma_f32_16x16x32_bf16 v[224:227], v[200:203], v[68:71], 0
  v_mfma_f32_16x16x32_bf16 v[60:63], v[208:211], v[68:71], 0
  v_mfma_f32_16x16x32_bf16 v[228:231], v[216:219], v[68:71], 0
  v_mfma_f32_16x16x32_bf16 v[56:59], v[196:199], v[72:75], v[56:59]
  v_mfma_f32_16x16x32_bf16 v[224:227], v[204:207], v[72:75], v[224:227]
  v_mfma_f32_16x16x32_bf16 v[60:63], v[212:215], v[72:75], v[60:63]
  v_mfma_f32_16x16x32_bf16 v[228:231], v[220:223], v[72:75], v[228:231]
  s_nop 5
  v_permlane32_swap_b32 v56, v224
  v_permlane32_swap_b32 v57, v225
  v_permlane32_swap_b32 v58, v226
  v_permlane32_swap_b32 v59, v227
  v_permlane32_swap_b32 v60, v228
  v_permlane32_swap_b32 v61, v229
  v_permlane32_swap_b32 v62, v230
  v_permlane32_swap_b32 v63, v231
  v_add_f32_dpp v56, v224, v56 row_ror:4 row_mask:0xf bank_mask:0xf
  v_add_f32_dpp v57, v225, v57 row_ror:4 row_mask:0xf bank_mask:0xf
  v_add_f32_dpp v58, v226, v58 row_ror:4 row_mask:0xf bank_mask:0xf
  v_add_f32_dpp v59, v227, v59 row_ror:4 row_mask:0xf bank_mask:0xf
  v_add_f32_dpp v60, v228, v60 row_ror:4 row_mask:0xf bank_mask:0xf
  v_add_f32_dpp v61, v229, v61 row_ror:4 row_mask:0xf bank_mask:0xf
  v_add_f32_dpp v62, v230, v62 row_ror:4 row_mask:0xf bank_mask:0xf
  v_add_f32_dpp v63, v231, v63 row_ror:4 row_mask:0xf bank_mask:0xf
  v_cvt_pk_bf16_f32 v78, v56, v57
  v_cvt_pk_bf16_f32 v79, v58, v59
  v_cvt_pk_bf16_f32 v80, v60, v61
  v_cvt_pk_bf16_f32 v81, v62, v63
  v_lshlrev_b32 v56, 16, v78
  v_and_b32 v57, s79, v78
  v_lshlrev_b32 v58, 16, v79
  v_and_b32 v59, s79, v79
  v_lshlrev_b32 v60, 16, v80
  v_and_b32 v61, s79, v80
  v_lshlrev_b32 v62, 16, v81
  v_and_b32 v63, s79, v81
  v_pk_mul_f32 v[56:57], v[56:57], v[232:233]
  v_pk_mul_f32 v[58:59], v[58:59], v[232:233]
  v_pk_mul_f32 v[60:61], v[60:61], v[232:233]
  v_pk_mul_f32 v[62:63], v[62:63], v[232:233]
  v_cvt_pk_bf16_f32 v64, v56, v57
  v_cvt_pk_bf16_f32 v65, v58, v59
  v_cvt_pk_bf16_f32 v66, v60, v61
  v_cvt_pk_bf16_f32 v67, v62, v63
  s_mov_b32 exec_lo, 0x000f000f
  s_mov_b32 exec_hi, 0x000f000f
  ds_write_b128 v94, v[64:67] offset:256
  ds_write_b32 v94, v232 offset:512
  s_mov_b64 exec, -1
  s_add_u32 s77, s77, 7
  v_lshlrev_b32 v160, 14, v0
  v_add_u32 v160, 491520, v160
  v_cmp_le_u32 vcc, 2, v0
  v_add_u32 v161, 475136, v160
  s_nop 0
  v_cndmask_b32 v160, v160, v161, vcc
  v_cmp_le_u32 vcc, 5, v0
  v_add_u32 v161, 475136, v160
  s_nop 0
  v_cndmask_b32 v160, v160, v161, vcc
  v_cmp_le_u32 vcc, 8, v0
  v_add_u32 v161, 458752, v160
  s_nop 0
  v_cndmask_b32 v160, v160, v161, vcc
  v_cmp_le_u32 vcc, 12, v0
  v_add_u32 v161, 458752, v160
  s_nop 0
  v_cndmask_b32 v160, v160, v161, vcc
  v_cmp_le_u32 vcc, 16, v0
  v_add_u32 v161, 458752, v160
  s_nop 0
  v_cndmask_b32 v160, v160, v161, vcc
  v_cmp_le_u32 vcc, 20, v0
  v_add_u32 v161, 442368, v160
  s_nop 0
  v_cndmask_b32 v160, v160, v161, vcc
  v_cmp_le_u32 vcc, 25, v0
  v_add_u32 v161, 458752, v160
  s_nop 0
  v_cndmask_b32 v160, v160, v161, vcc
  v_cmp_le_u32 vcc, 29, v0
  v_add_u32 v161, 475136, v160
  s_nop 0
  v_cndmask_b32 v160, v160, v161, vcc
L_kc1:
  s_lshl_b32 s69, s77, 10
  v_add_u32 v94, s69, v95
  s_waitcnt vmcnt(8)
  v_mfma_f32_16x16x32_bf16 v[56:59], v[96:99], v[68:71], 0
  v_mfma_f32_16x16x32_bf16 v[224:227], v[104:107], v[68:71], 0
  v_mfma_f32_16x16x32_bf16 v[60:63], v[112:115], v[68:71], 0
  v_mfma_f32_16x16x32_bf16 v[228:231], v[120:123], v[68:71], 0
  v_mfma_f32_16x16x32_bf16 v[56:59], v[100:103], v[72:75], v[56:59]
  v_mfma_f32_16x16x32_bf16 v[224:227], v[108:111], v[72:75], v[224:227]
  v_mfma_f32_16x16x32_bf16 v[60:63], v[116:119], v[72:75], v[60:63]
  v_mfma_f32_16x16x32_bf16 v[228:231], v[124:127], v[72:75], v[228:231]
  s_nop 5
  v_permlane32_swap_b32 v56, v224
  v_permlane32_swap_b32 v57, v225
  v_permlane32_swap_b32 v58, v226
  v_permlane32_swap_b32 v59, v227
  v_permlane32_swap_b32 v60, v228
  v_permlane32_swap_b32 v61, v229
  v_permlane32_swap_b32 v62, v230
  v_permlane32_swap_b32 v63, v231
  v_add_f32_dpp v56, v224, v56 row_ror:4 row_mask:0xf bank_mask:0xf
  v_add_f32_dpp v57, v225, v57 row_ror:4 row_mask:0xf bank_mask:0xf
  v_add_f32_dpp v58, v226, v58 row_ror:4 row_mask:0xf bank_mask:0xf
  v_add_f32_dpp v59, v227, v59 row_ror:4 row_mask:0xf bank_mask:0xf
  v_add_f32_dpp v60, v228, v60 row_ror:4 row_mask:0xf bank_mask:0xf
  v_add_f32_dpp v61, v229, v61 row_ror:4 row_mask:0xf bank_mask:0xf
  v_add_f32_dpp v62, v230, v62 row_ror:4 row_mask:0xf bank_mask:0xf
  v_add_f32_dpp v63, v231, v63 row_ror:4 row_mask:0xf bank_mask:0xf
  v_cvt_pk_bf16_f32 v78, v56, v57
  v_cvt_pk_bf16_f32 v79, v58, v59
  v_cvt_pk_bf16_f32 v80, v60, v61
  v_cvt_pk_bf16_f32 v81, v62, v63
  v_lshlrev_b32 v56, 16, v78
  v_and_b32 v57, s79, v78
  v_lshlrev_b32 v58, 16, v79
  v_and_b32 v59, s79, v79
  v_lshlrev_b32 v60, 16, v80
  v_and_b32 v61, s79, v80
  v_lshlrev_b32 v62, 16, v81
  v_and_b32 v63, s79, v81
  v_pk_mul_f32 v[56:57], v[56:57], v[232:233]
  v_pk_mul_f32 v[58:59], v[58:59], v[232:233]
  v_pk_mul_f32 v[60:61], v[60:61], v[232:233]
  v_pk_mul_f32 v[62:63], v[62:63], v[232:233]
  v_cvt_pk_bf16_f32 v64, v56, v57
  v_cvt_pk_bf16_f32 v65, v58, v59
  v_cvt_pk_bf16_f32 v66, v60, v61
  v_cvt_pk_bf16_f32 v67, v62, v63
  s_mov_b32 exec_lo, 0x000f000f
  s_mov_b32 exec_hi, 0x000f000f
  ds_write_b128 v94, v[64:67] offset:0
  s_mov_b64 exec, -1
  s_waitcnt vmcnt(0)
  v_mfma_f32_16x16x32_bf16 v[56:59], v[128:131], v[68:71], 0
  v_mfma_f32_16x16x32_bf16 v[224:227], v[136:139], v[68:71], 0
  v_mfma_f32_16x16x32_bf16 v[60:63], v[144:147], v[68:71], 0
  v_mfma_f32_16x16x32_bf16 v[228:231], v[152:155], v[68:71], 0
  v_mfma_f32_16x16x32_bf16 v[56:59], v[132:135], v[72:75], v[56:59]
  v_mfma_f32_16x16x32_bf16 v[224:227], v[140:143], v[72:75], v[224:227]
  v_mfma_f32_16x16x32_bf16 v[60:63], v[148:151], v[72:75], v[60:63]
  v_mfma_f32_16x16x32_bf16 v[228:231], v[156:159], v[72:75], v[228:231]
  s_nop 5
  v_permlane32_swap_b32 v56, v224
  v_permlane32_swap_b32 v57, v225
  v_permlane32_swap_b32 v58, v226
  v_permlane32_swap_b32 v59, v227
  v_permlane32_swap_b32 v60, v228
  v_permlane32_swap_b32 v61, v229
  v_permlane32_swap_b32 v62, v230
  v_permlane32_swap_b32 v63, v231
  v_add_f32_dpp v56, v224, v56 row_ror:4 row_mask:0xf bank_mask:0xf
  v_add_f32_dpp v57, v225, v57 row_ror:4 row_mask:0xf bank_mask:0xf
  v_add_f32_dpp v58, v226, v58 row_ror:4 row_mask:0xf bank_mask:0xf
  v_add_f32_dpp v59, v227, v59 row_ror:4 row_mask:0xf bank_mask:0xf
  v_add_f32_dpp v60, v228, v60 row_ror:4 row_mask:0xf bank_mask:0xf
  v_add_f32_dpp v61, v229, v61 row_ror:4 row_mask:0xf bank_mask:0xf
  v_add_f32_dpp v62, v230, v62 row_ror:4 row_mask:0xf bank_mask:0xf
  v_add_f32_dpp v63, v231, v63 row_ror:4 row_mask:0xf bank_mask:0xf
  v_cvt_pk_bf16_f32 v78, v56, v57
  v_cvt_pk_bf16_f32 v79, v58, v59
  v_cvt_pk_bf16_f32 v80, v60, v61
  v_cvt_pk_bf16_f32 v81, v62, v63
  v_lshlrev_b32 v56, 16, v78
  v_and_b32 v57, s79, v78
  v_lshlrev_b32 v58, 16, v79
  v_and_b32 v59, s79, v79
  v_lshlrev_b32 v60, 16, v80
  v_and_b32 v61, s79, v80
  v_lshlrev_b32 v62, 16, v81
  v_and_b32 v63, s79, v81
  v_pk_mul_f32 v[56:57], v[56:57], v[232:233]
  v_pk_mul_f32 v[58:59], v[58:59], v[232:233]
  v_pk_mul_f32 v[60:61], v[60:61], v[232:233]
  v_pk_mul_f32 v[62:63], v[62:63], v[232:233]
  v_cvt_pk_bf16_f32 v64, v56, v57
  v_cvt_pk_bf16_f32 v65, v58, v59
  v_cvt_pk_bf16_f32 v66, v60, v61
  v_cvt_pk_bf16_f32 v67, v62, v63
  s_mov_b32 exec_lo, 0x000f000f
  s_mov_b32 exec_hi, 0x000f000f
  ds_write_b128 v94, v[64:67] offset:256
  ds_write_b32 v94, v232 offset:512
  s_mov_b64 exec, -1
  s_branch L_next
L_kc:
  s_lshl_b32 s69, s77, 10
  v_add_u32 v94, s69, v95
  s_waitcnt vmcnt(8)
  v_mfma_f32_16x16x32_bf16 v[56:59], v[96:99], v[8:11], 0
  v_mfma_f32_16x16x32_bf16 v[60:63], v[112:115], v[8:11], 0
  v_mfma_f32_16x16x32_bf16 v[56:59], v[100:103], v[12:15], v[56:59]
  v_mfma_f32_16x16x32_bf16 v[60:63], v[116:119], v[12:15], v[60:63]
  v_mfma_f32_16x16x32_bf16 v[56:59], v[104:107], v[16:19], v[56:59]
  v_mfma_f32_16x16x32_bf16 v[60:63], v[120:123], v[16:19], v[60:63]
  v_mfma_f32_16x16x32_bf16 v[56:59], v[108:111], v[20:23], v[56:59]
  v_mfma_f32_16x16x32_bf16 v[60:63], v[124:127], v[20:23], v[60:63]
  s_nop 6
  v_cvt_pk_bf16_f32 v78, v56, v57
  v_cvt_pk_bf16_f32 v79, v58, v59
  v_cvt_pk_bf16_f32 v80, v60, v61
  v_cvt_pk_bf16_f32 v81, v62, v63
  v_lshlrev_b32 v56, 16, v78
  v_and_b32 v57, s79, v78
  v_lshlrev_b32 v58, 16, v79
  v_and_b32 v59, s79, v79
  v_lshlrev_b32 v60, 16, v80
  v_and_b32 v61, s79, v80
  v_lshlrev_b32 v62, 16, v81
  v_and_b32 v63, s79, v81
  v_pk_mul_f32 v[56:57], v[56:57], v[232:233]
  v_pk_mul_f32 v[58:59], v[58:59], v[232:233]
  v_pk_mul_f32 v[60:61], v[60:61], v[232:233]
  v_pk_mul_f32 v[62:63], v[62:63], v[232:233]
  v_cvt_pk_bf16_f32 v64, v56, v57
  v_cvt_pk_bf16_f32 v65, v58, v59
  v_cvt_pk_bf16_f32 v66, v60, v61
  v_cvt_pk_bf16_f32 v67, v62, v63
  s_mov_b32 exec_lo, 0x000f000f
  s_mov_b32 exec_hi, 0x000f000f
  ds_write_b128 v94, v[64:67] offset:0
  s_mov_b64 exec, -1
  s_waitcnt vmcnt(0)
  v_mfma_f32_16x16x32_bf16 v[56:59], v[128:131], v[68:71], 0
  v_mfma_f32_16x16x32_bf16 v[224:227], v[136:139], v[68:71], 0
  v_mfma_f32_16x16x32_bf16 v[60:63], v[144:147], v[68:71], 0
  v_mfma_f32_16x16x32_bf16 v[228:231], v[152:155], v[68:71], 0
  v_mfma_f32_16x16x32_bf16 v[56:59], v[132:135], v[72:75], v[56:59]
  v_mfma_f32_16x16x32_bf16 v[224:227], v[140:143], v[72:75], v[224:227]
  v_mfma_f32_16x16x32_bf16 v[60:63], v[148:151], v[72:75], v[60:63]
  v_mfma_f32_16x16x32_bf16 v[228:231], v[156:159], v[72:75], v[228:231]
  s_nop 5
  v_permlane32_swap_b32 v56, v224
  v_permlane32_swap_b32 v57, v225
  v_permlane32_swap_b32 v58, v226
  v_permlane32_swap_b32 v59, v227
  v_permlane32_swap_b32 v60, v228
  v_permlane32_swap_b32 v61, v229
  v_permlane32_swap_b32 v62, v230
  v_permlane32_swap_b32 v63, v231
  v_add_f32_dpp v56, v224, v56 row_ror:4 row_mask:0xf bank_mask:0xf
  v_add_f32_dpp v57, v225, v57 row_ror:4 row_mask:0xf bank_mask:0xf
  v_add_f32_dpp v58, v226, v58 row_ror:4 row_mask:0xf bank_mask:0xf
  v_add_f32_dpp v59, v227, v59 row_ror:4 row_mask:0xf bank_mask:0xf
  v_add_f32_dpp v60, v228, v60 row_ror:4 row_mask:0xf bank_mask:0xf
  v_add_f32_dpp v61, v229, v61 row_ror:4 row_mask:0xf bank_mask:0xf
  v_add_f32_dpp v62, v230, v62 row_ror:4 row_mask:0xf bank_mask:0xf
  v_add_f32_dpp v63, v231, v63 row_ror:4 row_mask:0xf bank_mask:0xf
  v_cvt_pk_bf16_f32 v78, v56, v57
  v_cvt_pk_bf16_f32 v79, v58, v59
  v_cvt_pk_bf16_f32 v80, v60, v61
  v_cvt_pk_bf16_f32 v81, v62, v63
  v_lshlrev_b32 v56, 16, v78
  v_and_b32 v57, s79, v78
  v_lshlrev_b32 v58, 16, v79
  v_and_b32 v59, s79, v79
  v_lshlrev_b32 v60, 16, v80
  v_and_b32 v61, s79, v80
  v_lshlrev_b32 v62, 16, v81
  v_and_b32 v63, s79, v81
  v_pk_mul_f32 v[56:57], v[56:57], v[232:233]
  v_pk_mul_f32 v[58:59], v[58:59], v[232:233]
  v_pk_mul_f32 v[60:61], v[60:61], v[232:233]
  v_pk_mul_f32 v[62:63], v[62:63], v[232:233]
  v_cvt_pk_bf16_f32 v64, v56, v57
  v_cvt_pk_bf16_f32 v65, v58, v59
  v_cvt_pk_bf16_f32 v66, v60, v61
  v_cvt_pk_bf16_f32 v67, v62, v63
  s_mov_b32 exec_lo, 0x000f000f
  s_mov_b32 exec_hi, 0x000f000f
  ds_write_b128 v94, v[64:67] offset:256
  ds_write_b32 v94, v232 offset:512
  s_mov_b64 exec, -1
L_next:
  s_cmp_lg_u32 s31, 0
  s_cbranch_scc1 L_hnext
  s_cmp_ge_u32 s30, s28
  s_cbranch_scc1 L_v
  s_lshl_b32 s67, s30, 1
  s_add_u32 s67, s67, s29
  s_lshl_b32 s67, s67, 13
  s_add_u32 s70, s67, 8192
  s_sub_u32 s68, s62, 3
  s_cmp_ge_u32 s68, 4
  s_cbranch_scc1 kf_46
  buffer_load_dwordx4 v[96:99], v86, s[8:11], s67 offen offset:0 nt
  buffer_load_dwordx4 v[100:103], v86, s[8:11], s67 offen offset:128 nt
  buffer_load_dwordx4 v[104:107], v86, s[8:11], s67 offen offset:512 nt
  buffer_load_dwordx4 v[108:111], v86, s[8:11], s67 offen offset:640 nt
  buffer_load_dwordx4 v[112:115], v87, s[8:11], s67 offen offset:0 nt
  buffer_load_dwordx4 v[116:119], v87, s[8:11], s67 offen offset:128 nt
  buffer_load_dwordx4 v[120:123], v87, s[8:11], s67 offen offset:512 nt
  buffer_load_dwordx4 v[124:127], v87, s[8:11], s67 offen offset:640 nt
  buffer_load_dwordx4 v[128:131], v86, s[8:11], s70 offen offset:0 nt
  buffer_load_dwordx4 v[132:135], v86, s[8:11], s70 offen offset:128 nt
  buffer_load_dwordx4 v[136:139], v86, s[8:11], s70 offen offset:512 nt
  buffer_load_dwordx4 v[140:143], v86, s[8:11], s70 offen offset:640 nt
  buffer_load_dwordx4 v[144:147], v87, s[8:11], s70 offen offset:0 nt
  buffer_load_dwordx4 v[148:151], v87, s[8:11], s70 offen offset:128 nt
  buffer_load_dwordx4 v[152:155], v87, s[8:11], s70 offen offset:512 nt
  buffer_load_dwordx4 v[156:159], v87, s[8:11], s70 offen offset:640 nt
  s_mov_b32 s77, s30
  s_mov_b32 s30, 1024
  s_cmp_lt_u32 s3, 4
  s_cbranch_scc1 dd_48
  s_cmp_lg_u32 s31, 0
  s_cbranch_scc1 dg_47
  v_mov_b32 v6, 1
  s_mov_b64 exec, 1
  ds_add_rtn_u32 v6, v5, v6 offset:1032
  s_mov_b64 exec, -1
  s_waitcnt lgkmcnt(0)
  v_readfirstlane_b32 s68, v6
  s_nop 0
  s_mov_b32 s30, s68
  s_lshr_b32 s68, s68, 1
  s_cmp_lt_u32 s68, s28
  s_cbranch_scc1 dd_48
  s_mov_b32 s30, 1024
  s_cmp_lg_u32 s75, 0
  s_cbranch_scc1 dd_48
  s_mov_b32 s31, 1
dg_47:
  v_mov_b32 v6, 1
  s_mov_b64 exec, 1
  buffer_atomic_add v6, off, s[16:19], s65 sc0 sc1
  s_mov_b64 exec, -1
dd_48:
  s_branch L_kc1
kf_46:
  buffer_load_dwordx4 v[96:99], v1, s[8:11], s67 offen offset:0 nt
  buffer_load_dwordx4 v[100:103], v1, s[8:11], s67 offen offset:64 nt
  buffer_load_dwordx4 v[104:107], v1, s[8:11], s67 offen offset:128 nt
  buffer_load_dwordx4 v[108:111], v1, s[8:11], s67 offen offset:192 nt
  buffer_load_dwordx4 v[112:115], v2, s[8:11], s67 offen offset:0 nt
  buffer_load_dwordx4 v[116:119], v2, s[8:11], s67 offen offset:64 nt
  buffer_load_dwordx4 v[120:123], v2, s[8:11], s67 offen offset:128 nt
  buffer_load_dwordx4 v[124:127], v2, s[8:11], s67 offen offset:192 nt
  buffer_load_dwordx4 v[128:131], v86, s[8:11], s70 offen offset:0 nt
  buffer_load_dwordx4 v[132:135], v86, s[8:11], s70 offen offset:128 nt
  buffer_load_dwordx4 v[136:139], v86, s[8:11], s70 offen offset:512 nt
  buffer_load_dwordx4 v[140:143], v86, s[8:11], s70 offen offset:640 nt
  buffer_load_dwordx4 v[144:147], v87, s[8:11], s70 offen offset:0 nt
  buffer_load_dwordx4 v[148:151], v87, s[8:11], s70 offen offset:128 nt
  buffer_load_dwordx4 v[152:155], v87, s[8:11], s70 offen offset:512 nt
  buffer_load_dwordx4 v[156:159], v87, s[8:11], s70 offen offset:640 nt
  s_mov_b32 s77, s30
  s_mov_b32 s30, 1024
  s_cmp_lt_u32 s3, 4
  s_cbranch_scc1 dd_50
  s_cmp_lg_u32 s31, 0
  s_cbranch_scc1 dg_49
  v_mov_b32 v6, 1
  s_mov_b64 exec, 1
  ds_add_rtn_u32 v6, v5, v6 offset:1032
  s_mov_b64 exec, -1
  s_waitcnt lgkmcnt(0)
  v_readfirstlane_b32 s68, v6
  s_nop 0
  s_mov_b32 s30, s68
  s_lshr_b32 s68, s68, 1
  s_cmp_lt_u32 s68, s28
  s_cbranch_scc1 dd_50
  s_mov_b32 s30, 1024
  s_cmp_lg_u32 s75, 0
  s_cbranch_scc1 dd_50
  s_mov_b32 s31, 1
dg_49:
  v_mov_b32 v6, 1
  s_mov_b64 exec, 1
  buffer_atomic_add v6, off, s[16:19], s65 sc0 sc1
  s_mov_b64 exec, -1
dd_50:
  s_branch L_kc
L_v:
  s_cmp_ge_u32 s30, 1024
  s_cbranch_scc1 L_sdone
  s_sub_u32 s30, s30, s28
  s_lshl_b32 s67, s30, 1
  s_add_u32 s67, s67, s29
  s_lshl_b32 s67, s67, 13
  s_add_u32 s70, s67, 8192
  s_mov_b32 exec_lo, 0x0f0f0f0f
  s_mov_b32 exec_hi, 0x0f0f0f0f
  buffer_load_dwordx4 v[96:99], v3, s[12:15], s67 offen offset:0 nt
  buffer_load_dwordx4 v[100:103], v3, s[12:15], s67 offen offset:1024 nt
  s_mov_b32 exec_lo, 0xf0f0f0f0
  s_mov_b32 exec_hi, 0xf0f0f0f0
  buffer_load_dwordx4 v[96:99], v3, s[12:15], s67 offen offset:0 nt
  buffer_load_dwordx4 v[100:103], v3, s[12:15], s67 offen offset:1024 nt
  s_mov_b64 exec, -1
  buffer_load_dwordx4 v[104:107], v3, s[12:15], s67 offen offset:2048 nt
  buffer_load_dwordx4 v[108:111], v3, s[12:15], s67 offen offset:3072 nt
  buffer_load_dwordx4 v[112:115], v4, s[12:15], s67 offen offset:0 nt
  buffer_load_dwordx4 v[116:119], v4, s[12:15], s67 offen offset:1024 nt
  buffer_load_dwordx4 v[120:123], v4, s[12:15], s67 offen offset:2048 nt
  buffer_load_dwordx4 v[124:127], v4, s[12:15], s67 offen offset:3072 nt
  buffer_load_dwordx4 v[128:131], v3, s[12:15], s70 offen offset:0 nt
  buffer_load_dwordx4 v[132:135], v3, s[12:15], s70 offen offset:1024 nt
  buffer_load_dwordx4 v[136:139], v3, s[12:15], s70 offen offset:2048 nt
  buffer_load_dwordx4 v[140:143], v3, s[12:15], s70 offen offset:3072 nt
  buffer_load_dwordx4 v[144:147], v4, s[12:15], s70 offen offset:0 nt
  buffer_load_dwordx4 v[148:151], v4, s[12:15], s70 offen offset:1024 nt
  buffer_load_dwordx4 v[152:155], v4, s[12:15], s70 offen offset:2048 nt
  buffer_load_dwordx4 v[156:159], v4, s[12:15], s70 offen offset:3072 nt
  s_lshl_b32 s69, s30, 10
  v_add_u32 v94, s69, v95
  v_mov_b32 v79, s69
  ds_read_b32 v78, v79 offset:29184
  ds_read_b128 v[232:235], v94
  ds_read_b128 v[236:239], v94 offset:256
  s_mov_b32 s30, 1024
  s_cmp_lt_u32 s3, 4
  s_cbranch_scc1 dd_52
  s_cmp_lg_u32 s31, 0
  s_cbranch_scc1 dg_51
  v_mov_b32 v6, 1
  s_mov_b64 exec, 1
  ds_add_rtn_u32 v6, v5, v6 offset:1032
  s_mov_b64 exec, -1
  s_waitcnt lgkmcnt(0)
  v_readfirstlane_b32 s68, v6
  s_nop 0
  s_mov_b32 s30, s68
  s_lshr_b32 s68, s68, 1
  s_cmp_lt_u32 s68, s28
  s_cbranch_scc1 dd_52
  s_mov_b32 s30, 1024
  s_cmp_lg_u32 s75, 0
  s_cbranch_scc1 dd_52
  s_mov_b32 s31, 1
dg_51:
  v_mov_b32 v6, 1
  s_mov_b64 exec, 1
  buffer_atomic_add v6, off, s[16:19], s65 sc0 sc1
  s_mov_b64 exec, -1
dd_52:
  s_mov_b32 s78, 400000
vf_53:
  s_waitcnt lgkmcnt(0)
  v_cmp_ne_u32 vcc, 0, v78
  s_cbranch_vccnz vfd_54
  ds_read_b32 v78, v79 offset:29184
  ds_read_b128 v[232:235], v94
  ds_read_b128 v[236:239], v94 offset:256
  s_sub_u32 s78, s78, 1
  s_cmp_lg_u32 s78, 0
  s_cbranch_scc1 vf_53
vfd_54:
  v_lshlrev_b32 v56, 16, v232
  v_and_b32 v57, s79, v232
  v_lshlrev_b32 v58, 16, v233
  v_and_b32 v59, s79, v233
  v_lshlrev_b32 v60, 16, v234
  v_and_b32 v61, s79, v234
  v_lshlrev_b32 v62, 16, v235
  v_and_b32 v63, s79, v235
  v_lshlrev_b32 v224, 16, v236
  v_and_b32 v225, s79, v236
  v_lshlrev_b32 v226, 16, v237
  v_and_b32 v227, s79, v237
  v_lshlrev_b32 v228, 16, v238
  v_and_b32 v229, s79, v238
  v_lshlrev_b32 v230, 16, v239
  v_and_b32 v231, s79, v239
  v_max3_f32 v82, v56, v57, v76
  v_max3_f32 v83, v58, v59, v60
  v_max3_f32 v82, v82, v61, v62
  v_max3_f32 v83, v83, v63, v224
  v_max3_f32 v82, v82, v225, v226
  v_max3_f32 v83, v83, v227, v228
  v_max3_f32 v82, v82, v229, v230
  v_max_f32 v83, v83, v231
  v_max_f32 v82, v82, v83
  v_mov_b32 v83, v82
  s_nop 1
  v_permlane16_swap_b32 v82, v83
  v_max_f32 v82, v82, v83
  v_mov_b32 v83, v82
  s_nop 1
  v_permlane32_swap_b32 v82, v83
  v_max_f32 v82, v82, v83
  v_sub_f32 v84, v76, v82
  v_mul_f32 v85, s73, v82
  v_mul_f32 v84, s73, v84
  v_mov_b32 v76, v82
  v_exp_f32 v84, v84
  v_fma_f32 v56, v56, s73, -v85
  v_fma_f32 v57, v57, s73, -v85
  v_fma_f32 v58, v58, s73, -v85
  v_fma_f32 v59, v59, s73, -v85
  v_fma_f32 v60, v60, s73, -v85
  v_fma_f32 v61, v61, s73, -v85
  v_fma_f32 v62, v62, s73, -v85
  v_fma_f32 v63, v63, s73, -v85
  v_fma_f32 v224, v224, s73, -v85
  v_fma_f32 v225, v225, s73, -v85
  v_fma_f32 v226, v226, s73, -v85
  v_fma_f32 v227, v227, s73, -v85
  v_fma_f32 v228, v228, s73, -v85
  v_fma_f32 v229, v229, s73, -v85
  v_fma_f32 v230, v230, s73, -v85
  v_fma_f32 v231, v231, s73, -v85
  v_exp_f32 v56, v56
  v_exp_f32 v57, v57
  v_exp_f32 v58, v58
  v_exp_f32 v59, v59
  v_exp_f32 v60, v60
  v_exp_f32 v61, v61
  v_exp_f32 v62, v62
  v_exp_f32 v63, v63
  v_exp_f32 v224, v224
  v_exp_f32 v225, v225
  v_exp_f32 v226, v226
  v_exp_f32 v227, v227
  v_exp_f32 v228, v228
  v_exp_f32 v229, v229
  v_exp_f32 v230, v230
  v_exp_f32 v231, v231
  v_mul_f32 v77, v77, v84
  v_cmp_neq_f32 vcc, 1.0, v84
  s_cbranch_vccz nrs_55
  v_pk_mul_f32 v[24:25], v[24:25], v[84:85] op_sel_hi:[1,0]
  v_pk_mul_f32 v[26:27], v[26:27], v[84:85] op_sel_hi:[1,0]
  v_pk_mul_f32 v[28:29], v[28:29], v[84:85] op_sel_hi:[1,0]
  v_pk_mul_f32 v[30:31], v[30:31], v[84:85] op_sel_hi:[1,0]
  v_pk_mul_f32 v[32:33], v[32:33], v[84:85] op_sel_hi:[1,0]
  v_pk_mul_f32 v[34:35], v[34:35], v[84:85] op_sel_hi:[1,0]
  v_pk_mul_f32 v[36:37], v[36:37], v[84:85] op_sel_hi:[1,0]
  v_pk_mul_f32 v[38:39], v[38:39], v[84:85] op_sel_hi:[1,0]
  v_pk_mul_f32 v[40:41], v[40:41], v[84:85] op_sel_hi:[1,0]
  v_pk_mul_f32 v[42:43], v[42:43], v[84:85] op_sel_hi:[1,0]
  v_pk_mul_f32 v[44:45], v[44:45], v[84:85] op_sel_hi:[1,0]
  v_pk_mul_f32 v[46:47], v[46:47], v[84:85] op_sel_hi:[1,0]
  v_pk_mul_f32 v[48:49], v[48:49], v[84:85] op_sel_hi:[1,0]
  v_pk_mul_f32 v[50:51], v[50:51], v[84:85] op_sel_hi:[1,0]
  v_pk_mul_f32 v[52:53], v[52:53], v[84:85] op_sel_hi:[1,0]
  v_pk_mul_f32 v[54:55], v[54:55], v[84:85] op_sel_hi:[1,0]
nrs_55:
  v_cvt_pk_bf16_f32 v64, v56, v57
  v_cvt_pk_bf16_f32 v232, v224, v225
  v_cvt_pk_bf16_f32 v65, v58, v59
  v_cvt_pk_bf16_f32 v233, v226, v227
  v_cvt_pk_bf16_f32 v66, v60, v61
  v_cvt_pk_bf16_f32 v234, v228, v229
  v_cvt_pk_bf16_f32 v67, v62, v63
  v_cvt_pk_bf16_f32 v235, v230, v231
  v_pk_add_f32 v[56:57], v[56:57], v[224:225]
  v_pk_add_f32 v[58:59], v[58:59], v[226:227]
  v_pk_add_f32 v[60:61], v[60:61], v[228:229]
  v_pk_add_f32 v[62:63], v[62:63], v[230:231]
  v_pk_add_f32 v[56:57], v[56:57], v[58:59]
  v_pk_add_f32 v[60:61], v[60:61], v[62:63]
  v_pk_add_f32 v[56:57], v[56:57], v[60:61]
  v_add_f32 v77, v77, v56
  v_add_f32 v77, v77, v57
  s_waitcnt vmcnt(8)
  v_perm_b32 v68, v100, v96, s71
  v_perm_b32 v69, v108, v104, s71
  v_perm_b32 v70, v116, v112, s71
  v_perm_b32 v71, v124, v120, s71
  v_perm_b32 v72, v100, v96, s72
  v_perm_b32 v73, v108, v104, s72
  v_perm_b32 v74, v116, v112, s72
  v_perm_b32 v75, v124, v120, s72
  v_mfma_f32_16x16x32_bf16 v[24:27], v[68:71], v[64:67], v[24:27]
  v_perm_b32 v68, v101, v97, s71
  v_perm_b32 v69, v109, v105, s71
  v_perm_b32 v70, v117, v113, s71
  v_perm_b32 v71, v125, v121, s71
  v_mfma_f32_16x16x32_bf16 v[28:31], v[72:75], v[64:67], v[28:31]
  v_perm_b32 v72, v101, v97, s72
  v_perm_b32 v73, v109, v105, s72
  v_perm_b32 v74, v117, v113, s72
  v_perm_b32 v75, v125, v121, s72
  v_mfma_f32_16x16x32_bf16 v[32:35], v[68:71], v[64:67], v[32:35]
  v_perm_b32 v68, v102, v98, s71
  v_perm_b32 v69, v110, v106, s71
  v_perm_b32 v70, v118, v114, s71
  v_perm_b32 v71, v126, v122, s71
  v_mfma_f32_16x16x32_bf16 v[36:39], v[72:75], v[64:67], v[36:39]
  v_perm_b32 v72, v102, v98, s72
  v_perm_b32 v73, v110, v106, s72
  v_perm_b32 v74, v118, v114, s72
  v_perm_b32 v75, v126, v122, s72
  v_mfma_f32_16x16x32_bf16 v[40:43], v[68:71], v[64:67], v[40:43]
  v_perm_b32 v68, v103, v99, s71
  v_perm_b32 v69, v111, v107, s71
  v_perm_b32 v70, v119, v115, s71
  v_perm_b32 v71, v127, v123, s71
  v_mfma_f32_16x16x32_bf16 v[44:47], v[72:75], v[64:67], v[44:47]
  v_perm_b32 v72, v103, v99, s72
  v_perm_b32 v73, v111, v107, s72
  v_perm_b32 v74, v119, v115, s72
  v_perm_b32 v75, v127, v123, s72
  v_mfma_f32_16x16x32_bf16 v[48:51], v[68:71], v[64:67], v[48:51]
  s_nop 0
  v_mfma_f32_16x16x32_bf16 v[52:55], v[72:75], v[64:67], v[52:55]
  s_waitcnt vmcnt(0)
  v_perm_b32 v68, v132, v128, s71
  v_perm_b32 v69, v140, v136, s71
  v_perm_b32 v70, v148, v144, s71
  v_perm_b32 v71, v156, v152, s71
  v_perm_b32 v72, v132, v128, s72
  v_perm_b32 v73, v140, v136, s72
  v_perm_b32 v74, v148, v144, s72
  v_perm_b32 v75, v156, v152, s72
  v_mfma_f32_16x16x32_bf16 v[24:27], v[68:71], v[232:235], v[24:27]
  v_perm_b32 v68, v133, v129, s71
  v_perm_b32 v69, v141, v137, s71
  v_perm_b32 v70, v149, v145, s71
  v_perm_b32 v71, v157, v153, s71
  v_mfma_f32_16x16x32_bf16 v[28:31], v[72:75], v[232:235], v[28:31]
  v_perm_b32 v72, v133, v129, s72
  v_perm_b32 v73, v141, v137, s72
  v_perm_b32 v74, v149, v145, s72
  v_perm_b32 v75, v157, v153, s72
  v_mfma_f32_16x16x32_bf16 v[32:35], v[68:71], v[232:235], v[32:35]
  v_perm_b32 v68, v134, v130, s71
  v_perm_b32 v69, v142, v138, s71
  v_perm_b32 v70, v150, v146, s71
  v_perm_b32 v71, v158, v154, s71
  v_mfma_f32_16x16x32_bf16 v[36:39], v[72:75], v[232:235], v[36:39]
  v_perm_b32 v72, v134, v130, s72
  v_perm_b32 v73, v142, v138, s72
  v_perm_b32 v74, v150, v146, s72
  v_perm_b32 v75, v158, v154, s72
  v_mfma_f32_16x16x32_bf16 v[40:43], v[68:71], v[232:235], v[40:43]
  v_perm_b32 v68, v135, v131, s71
  v_perm_b32 v69, v143, v139, s71
  v_perm_b32 v70, v151, v147, s71
  v_perm_b32 v71, v159, v155, s71
  v_mfma_f32_16x16x32_bf16 v[44:47], v[72:75], v[232:235], v[44:47]
  v_perm_b32 v72, v135, v131, s72
  v_perm_b32 v73, v143, v139, s72
  v_perm_b32 v74, v151, v147, s72
  v_perm_b32 v75, v159, v155, s72
  v_mfma_f32_16x16x32_bf16 v[48:51], v[68:71], v[232:235], v[48:51]
  s_nop 0
  v_mfma_f32_16x16x32_bf16 v[52:55], v[72:75], v[232:235], v[52:55]
  s_branch L_next
L_hnext:
  s_waitcnt vmcnt(0)
  v_readfirstlane_b32 s67, v6
  s_nop 0
  s_cmp_ge_u32 s67, 128
  s_cbranch_scc1 L_sdone
  s_lshr_b32 s68, s67, 2
  v_readlane_b32 s69, v160, s68
  s_and_b32 s68, s67, 3
  s_lshl_b32 s68, s68, 12
  s_add_u32 s68, s68, s69
  s_lshl_b32 s67, s67, 12
  s_add_u32 s67, s67, 7864320
  buffer_load_dwordx4 v[96:99], v1, s[8:11], s68 offen offset:0 nt
  buffer_load_dwordx4 v[100:103], v1, s[8:11], s68 offen offset:64 nt
  buffer_load_dwordx4 v[104:107], v1, s[8:11], s68 offen offset:128 nt
  buffer_load_dwordx4 v[108:111], v1, s[8:11], s68 offen offset:192 nt
  buffer_load_dwordx4 v[128:131], v3, s[12:15], s68 offen offset:0 nt
  buffer_load_dwordx4 v[132:135], v3, s[12:15], s68 offen offset:1024 nt
  buffer_load_dwordx4 v[136:139], v3, s[12:15], s68 offen offset:2048 nt
  buffer_load_dwordx4 v[140:143], v3, s[12:15], s68 offen offset:3072 nt
  s_cmp_ge_u32 s67, s76
  s_cbranch_scc1 lim_56
  v_mov_b32 v6, 1
  s_mov_b64 exec, 1
  buffer_atomic_add v6, off, s[16:19], s65 sc0 sc1
  s_mov_b64 exec, -1
  s_branch lim_57
lim_56:
  v_mov_b32 v6, 0x1000
  s_mov_b64 exec, 1
  buffer_load_dword v94, off, s[12:15], s68 nt
  s_mov_b64 exec, -1
lim_57:
  s_waitcnt vmcnt(5)
  v_mfma_f32_16x16x32_bf16 v[56:59], v[96:99], v[8:11], 0
  v_mfma_f32_16x16x32_bf16 v[56:59], v[100:103], v[12:15], v[56:59]
  v_mfma_f32_16x16x32_bf16 v[56:59], v[104:107], v[16:19], v[56:59]
  v_mfma_f32_16x16x32_bf16 v[56:59], v[108:111], v[20:23], v[56:59]
  s_nop 7
  v_cvt_pk_bf16_f32 v78, v56, v57
  v_cvt_pk_bf16_f32 v79, v58, v59
  v_lshlrev_b32 v56, 16, v78
  v_and_b32 v57, s79, v78
  v_lshlrev_b32 v58, 16, v79
  v_and_b32 v59, s79, v79
  v_mul_f32 v56, s74, v56
  v_mul_f32 v57, s74, v57
  v_mul_f32 v58, s74, v58
  v_mul_f32 v59, s74, v59
  v_cvt_pk_bf16_f32 v78, v56, v57
  v_cvt_pk_bf16_f32 v79, v58, v59
  v_lshlrev_b32 v56, 16, v78
  v_and_b32 v57, s79, v78
  v_lshlrev_b32 v58, 16, v79
  v_and_b32 v59, s79, v79
  v_max3_f32 v82, v56, v57, v58
  v_max3_f32 v82, v82, v59, v76
  v_mov_b32 v83, v82
  s_nop 1
  v_permlane16_swap_b32 v82, v83
  v_max_f32 v82, v82, v83
  v_mov_b32 v83, v82
  s_nop 1
  v_permlane32_swap_b32 v82, v83
  v_max_f32 v82, v82, v83
  v_sub_f32 v84, v76, v82
  v_mul_f32 v85, s73, v82
  v_mul_f32 v84, s73, v84
  v_mov_b32 v76, v82
  v_exp_f32 v84, v84
  v_fma_f32 v56, v56, s73, -v85
  v_fma_f32 v57, v57, s73, -v85
  v_fma_f32 v58, v58, s73, -v85
  v_fma_f32 v59, v59, s73, -v85
  v_exp_f32 v56, v56
  v_exp_f32 v57, v57
  v_exp_f32 v58, v58
  v_exp_f32 v59, v59
  v_mul_f32 v77, v77, v84
  v_cmp_neq_f32 vcc, 1.0, v84
  s_cbranch_vccz nrs_58
  v_pk_mul_f32 v[24:25], v[24:25], v[84:85] op_sel_hi:[1,0]
  v_pk_mul_f32 v[26:27], v[26:27], v[84:85] op_sel_hi:[1,0]
  v_pk_mul_f32 v[28:29], v[28:29], v[84:85] op_sel_hi:[1,0]
  v_pk_mul_f32 v[30:31], v[30:31], v[84:85] op_sel_hi:[1,0]
  v_pk_mul_f32 v[32:33], v[32:33], v[84:85] op_sel_hi:[1,0]
  v_pk_mul_f32 v[34:35], v[34:35], v[84:85] op_sel_hi:[1,0]
  v_pk_mul_f32 v[36:37], v[36:37], v[84:85] op_sel_hi:[1,0]
  v_pk_mul_f32 v[38:39], v[38:39], v[84:85] op_sel_hi:[1,0]
  v_pk_mul_f32 v[40:41], v[40:41], v[84:85] op_sel_hi:[1,0]
  v_pk_mul_f32 v[42:43], v[42:43], v[84:85] op_sel_hi:[1,0]
  v_pk_mul_f32 v[44:45], v[44:45], v[84:85] op_sel_hi:[1,0]
  v_pk_mul_f32 v[46:47], v[46:47], v[84:85] op_sel_hi:[1,0]
  v_pk_mul_f32 v[48:49], v[48:49], v[84:85] op_sel_hi:[1,0]
  v_pk_mul_f32 v[50:51], v[50:51], v[84:85] op_sel_hi:[1,0]
  v_pk_mul_f32 v[52:53], v[52:53], v[84:85] op_sel_hi:[1,0]
  v_pk_mul_f32 v[54:55], v[54:55], v[84:85] op_sel_hi:[1,0]
nrs_58:
  v_cvt_pk_bf16_f32 v64, v56, v57
  v_cvt_pk_bf16_f32 v65, v58, v59
  v_add_f32 v78, v56, v57
  v_add_f32 v79, v58, v59
  v_add_f32 v77, v77, v78
  v_add_f32 v77, v77, v79
  s_waitcnt vmcnt(1)
  v_perm_b32 v68, v132, v128, s71
  v_perm_b32 v69, v140, v136, s71
  v_perm_b32 v70, v132, v128, s72
  v_perm_b32 v71, v140, v136, s72
  v_perm_b32 v72, v133, v129, s71
  v_perm_b32 v73, v141, v137, s71
  v_mfma_f32_16x16x16_bf16 v[24:27], v[68:69], v[64:65], v[24:27]
  v_perm_b32 v74, v133, v129, s72
  v_perm_b32 v75, v141, v137, s72
  v_mfma_f32_16x16x16_bf16 v[28:31], v[70:71], v[64:65], v[28:31]
  v_perm_b32 v68, v134, v130, s71
  v_perm_b32 v69, v142, v138, s71
  v_mfma_f32_16x16x16_bf16 v[32:35], v[72:73], v[64:65], v[32:35]
  v_perm_b32 v70, v134, v130, s72
  v_perm_b32 v71, v142, v138, s72
  v_mfma_f32_16x16x16_bf16 v[36:39], v[74:75], v[64:65], v[36:39]
  v_perm_b32 v72, v135, v131, s71
  v_perm_b32 v73, v143, v139, s71
  v_mfma_f32_16x16x16_bf16 v[40:43], v[68:69], v[64:65], v[40:43]
  v_perm_b32 v74, v135, v131, s72
  v_perm_b32 v75, v143, v139, s72
  v_mfma_f32_16x16x16_bf16 v[44:47], v[70:71], v[64:65], v[44:47]
  v_mfma_f32_16x16x16_bf16 v[48:51], v[72:73], v[64:65], v[48:51]
  v_mfma_f32_16x16x16_bf16 v[52:55], v[74:75], v[64:65], v[52:55]
  s_branch L_hnext
L_sdone:
  s_cmp_lt_u32 s3, 1
  s_cbranch_scc1 now_59
  v_mul_f32 v76, s73, v76
  v_mov_b32 v78, v77
  s_mov_b32 exec_lo, 0x000f000f
  s_mov_b32 exec_hi, 0x000f000f
  ds_write_b128 v89, v[24:27] offset:12288
  ds_write_b128 v89, v[28:31] offset:12352
  ds_write_b128 v89, v[32:35] offset:12416
  ds_write_b128 v89, v[36:39] offset:12480
  s_mov_b64 exec, -1
  v_permlane16_swap_b32 v77, v78
  v_add_f32 v77, v77, v78
  v_mov_b32 v78, v77
  s_mov_b32 exec_lo, 0x000f000f
  s_mov_b32 exec_hi, 0x000f000f
  ds_write_b128 v89, v[40:43] offset:12544
  ds_write_b128 v89, v[44:47] offset:12608
  ds_write_b128 v89, v[48:51] offset:12672
  ds_write_b128 v89, v[52:55] offset:12736
  s_mov_b64 exec, -1
  v_permlane32_swap_b32 v77, v78
  v_add_f32 v77, v77, v78
  s_mov_b64 exec, 0xf
  ds_write2_b32 v88, v76, v77 offset0:64 offset1:96
  s_mov_b64 exec, -1
now_59:
  s_cmp_lg_u32 s3, 3
  s_cbranch_scc1 npz_60
  s_sub_u32 s4, s2, 112
  s_cmp_ge_u32 s4, 48
  s_cbranch_scc1 npz_60
  s_lshl_b32 s4, s2, 7
  s_and_b32 s5, s4, 0xffffe000
  s_add_u32 s4, s4, s5
  s_add_u32 s4, s4, 786432
  s_add_u32 s4, s16, s4
  s_addc_u32 s5, s17, 0
  s_mov_b32 s20, -1
  s_mov_b32 s21, -1
  s_mov_b32 s6, 16
npl_61:
  s_memtime s[22:23]
  s_waitcnt lgkmcnt(0)
  s_load_dword s7, s[4:5], 0 glc
  s_waitcnt lgkmcnt(0)
  s_memtime s[26:27]
  s_waitcnt lgkmcnt(0)
  s_sub_u32 s7, s26, s22
  s_min_u32 s20, s20, s7
  s_memtime s[22:23]
  s_waitcnt lgkmcnt(0)
  s_load_dword s7, s[4:5], 8192 glc
  s_waitcnt lgkmcnt(0)
  s_memtime s[26:27]
  s_waitcnt lgkmcnt(0)
  s_sub_u32 s7, s26, s22
  s_min_u32 s21, s21, s7
  s_sleep 4
  s_sub_u32 s6, s6, 1
  s_cmp_lg_u32 s6, 0
  s_cbranch_scc1 npl_61
  s_cmp_lt_u32 s21, s20
  s_cselect_b32 s4, 8192, 0
  v_mov_b32 v94, s4
  ds_write_b32 v5, v94 offset:1036
npz_60:
  s_waitcnt lgkmcnt(0)
  s_barrier
  s_cmp_lg_u32 s3, 4
  s_cbranch_scc1 nl4_62
L_dry0:
  ds_read2_b32 v[8:9], v93 offset0:0 offset1:32
  s_waitcnt lgkmcnt(0)
  v_max_f32_dpp v10, v8, v8 quad_perm:[1,0,3,2] row_mask:0xf bank_mask:0xf
  s_nop 1
  v_max_f32_dpp v10, v10, v10 quad_perm:[2,3,0,1] row_mask:0xf bank_mask:0xf
  s_nop 1
  v_max_f32_dpp v10, v10, v10 row_half_mirror row_mask:0xf bank_mask:0xf
  v_sub_f32 v8, v8, v10
  v_exp_f32 v8, v8
  s_nop 0
  v_mul_f32 v8, v8, v9
  s_nop 1
  v_add_f32_dpp v8, v8, v8 quad_perm:[1,0,3,2] row_mask:0xf bank_mask:0xf
  s_nop 1
  v_add_f32_dpp v8, v8, v8 quad_perm:[2,3,0,1] row_mask:0xf bank_mask:0xf
  s_nop 1
  v_add_f32_dpp v8, v8, v8 row_half_mirror row_mask:0xf bank_mask:0xf
  v_log_f32 v8, v8
  s_nop 0
  v_add_f32 v8, v8, v10
  s_and_b32 exec_lo, s100, 0xffffffff
  s_mov_b32 exec_hi, 0
  buffer_store_dword v8, v92, s[16:19], s25 offen sc1
  s_mov_b64 exec, s[100:101]
  s_cbranch_execz L_merge
  s_branch L_nomerge
nl4_62:
  s_cmp_ge_u32 s3, 4
  s_cbranch_scc1 L_nomerge
L_merge:
  ds_read_b128 v[8:11], v90 offset:1280
  ds_read_b128 v[12:15], v90 offset:1296
  ds_read_b128 v[16:19], v90 offset:1408
  ds_read_b128 v[20:23], v90 offset:1424
  ds_read_b64 v[98:99], v91 offset:14336
  ds_read_b64 v[100:101], v91 offset:16384
  ds_read_b64 v[102:103], v91 offset:18432
  ds_read_b64 v[104:105], v91 offset:20480
  ds_read_b64 v[106:107], v91 offset:22528
  ds_read_b64 v[108:109], v91 offset:24576
  ds_read_b64 v[110:111], v91 offset:26624
  s_waitcnt lgkmcnt(9)
  v_max3_f32 v40, v9, v10, v11
  v_max3_f32 v41, v12, v13, v14
  v_max3_f32 v40, v40, v41, v15
  v_sub_f32 v33, v9, v40
  v_pk_add_f32 v[34:35], v[10:11], v[40:41] op_sel_hi:[1,0] neg_lo:[0,1] neg_hi:[0,1]
  v_pk_add_f32 v[36:37], v[12:13], v[40:41] op_sel_hi:[1,0] neg_lo:[0,1] neg_hi:[0,1]
  v_pk_add_f32 v[38:39], v[14:15], v[40:41] op_sel_hi:[1,0] neg_lo:[0,1] neg_hi:[0,1]
  v_exp_f32 v33, v33
  v_exp_f32 v34, v34
  v_exp_f32 v35, v35
  v_exp_f32 v36, v36
  v_exp_f32 v37, v37
  v_exp_f32 v38, v38
  v_exp_f32 v39, v39
  s_waitcnt lgkmcnt(4)
  v_mul_f32 v41, v33, v17
  v_pk_mul_f32 v[44:45], v[34:35], v[18:19]
  v_pk_mul_f32 v[42:43], v[98:99], v[32:33] op_sel:[0,1] op_sel_hi:[1,1]
  v_pk_fma_f32 v[44:45], v[36:37], v[20:21], v[44:45]
  v_pk_mul_f32 v[48:49], v[100:101], v[34:35] op_sel_hi:[1,0]
  v_pk_fma_f32 v[44:45], v[38:39], v[22:23], v[44:45]
  v_pk_fma_f32 v[42:43], v[102:103], v[34:35], v[42:43] op_sel:[0,1,0] op_sel_hi:[1,1,1]
  v_add_f32 v41, v41, v44
  s_waitcnt lgkmcnt(2)
  v_pk_fma_f32 v[48:49], v[104:105], v[36:37], v[48:49] op_sel_hi:[1,0,1]
  v_add_f32 v41, v41, v45
  v_pk_fma_f32 v[42:43], v[106:107], v[36:37], v[42:43] op_sel:[0,1,0] op_sel_hi:[1,1,1]
  v_max_f32 v41, 0x00800000, v41
  s_waitcnt lgkmcnt(0)
  v_pk_fma_f32 v[48:49], v[108:109], v[38:39], v[48:49] op_sel_hi:[1,0,1]
  v_rcp_f32 v44, v41
  v_pk_fma_f32 v[42:43], v[110:111], v[38:39], v[42:43] op_sel:[0,1,0] op_sel_hi:[1,1,1]
  v_pk_add_f32 v[42:43], v[42:43], v[48:49]
  v_pk_mul_f32 v[42:43], v[42:43], v[44:45] op_sel_hi:[1,0]
  v_cvt_pk_bf16_f32 v42, v42, v43
  buffer_store_dword v42, v92, s[16:19], s24 offen sc1
L_nomerge:
  s_sub_u32 s67, s62, 3
  s_cmp_lt_u32 s67, 4
  s_cbranch_scc1 L_t1
  s_sub_u32 s67, s2, 112
  s_cmp_lt_u32 s67, 28
  s_cbranch_scc1 L_t2
  s_cmp_eq_u32 s62, 9
  s_cbranch_scc1 L_t3
  s_cmp_ge_u32 s3, 4
  s_cbranch_scc1 L_fin
  s_sub_u32 s4, s62, 8
  s_cmp_lt_u32 s62, 2
  s_cselect_b32 s4, s62, s4
  s_sub_u32 s5, s62, 2
  s_cmp_lt_u32 s5, 8
  s_cbranch_scc1 L_fin
  s_lshl_b32 s4, s4, 1
  s_bfe_u32 s5, s2, 0x10003
  s_add_u32 s70, s4, s5
  s_and_b32 s69, s2, 7
  v_lshrrev_b32 v8, 3, v0
  v_and_b32 v9, 7, v0
  v_lshlrev_b32 v9, 4, v9
  v_lshl_add_u32 v10, v8, 10, v9
  v_mul_u32_u24 v11, 3584, v8
  v_add_u32 v11, v11, v9
  s_lshr_b32 s7, s70, 3
  s_lshl_b32 s7, s7, 2
  s_add_u32 s7, s7, s3
  s_lshl_b32 s7, s7, 6
  s_mov_b32 s20, s48
  s_mov_b32 s21, s49
  s_mov_b32 s22, 1835008
  s_mov_b32 s23, 0x20000
  s_lshl_b32 s4, s70, 2
  s_add_u32 s4, s4, s3
  s_mul_i32 s4, s4, 28672
  s_lshl_b32 s5, s69, 7
  s_add_u32 s4, s4, s5
  s_add_u32 s5, s4, 0
  buffer_load_dwordx4 v[96:99], v10, s[20:23], s5 offen
  s_add_u32 s5, s4, 8192
  buffer_load_dwordx4 v[96:99], v10, s[20:23], s5 offen
  s_add_u32 s5, s4, 16384
  buffer_load_dwordx4 v[96:99], v10, s[20:23], s5 offen
  s_add_u32 s5, s4, 24576
  buffer_load_dwordx4 v[96:99], v10, s[20:23], s5 offen
  s_waitcnt vmcnt(0)
  s_branch L_fin
L_t1:
  s_lshr_b32 s75, s3, 1
  v_lshrrev_b32 v4, 4, v0
  v_lshlrev_b32 v40, 4, v0
  s_lshl_b32 s77, s3, 2
  s_lshr_b32 s4, s77, 4
  s_lshl_b32 s4, s4, 3
  s_add_u32 s4, s4, s64
  s_lshl_b32 s4, s4, 4
  s_and_b32 s5, s77, 15
  s_add_u32 s4, s4, s5
  s_lshl_b32 s67, s4, 10
  s_add_u32 s67, s67, 131072
  s_add_u32 s69, s67, 4096
  s_sub_u32 s7, s3, 0
  s_cmp_lt_u32 s7, 2
  s_cselect_b32 s70, 31, 15
  s_lshl_b32 s68, s64, 11
  s_lshl_b32 s5, s7, 6
  s_and_b32 s5, s5, 64
  s_add_u32 s68, s68, s5
  s_add_u32 s68, s68, 720896
  v_and_b32 v41, 15, v0
  v_lshlrev_b32 v41, 7, v41
  v_and_b32 v8, 1, v4
  v_lshl_add_u32 v41, v8, 14, v41
  v_lshrrev_b32 v9, 5, v0
  v_lshl_add_u32 v41, v9, 5, v41
  s_mov_b32 s78, 400000
  s_cbranch_execz t1c_65
  s_cmp_lt_u32 s3, 4
  s_cbranch_scc1 t1a_63
t1c_65:
  v_bfe_u32 v9, v0, 2, 1
  v_lshlrev_b32 v8, 3, v9
  v_bfe_u32 v9, v0, 3, 1
  v_lshl_add_u32 v8, v9, 1, v8
  v_and_b32 v9, 1, v4
  v_add_u32 v8, v8, v9
  v_lshrrev_b32 v9, 5, v0
  v_lshl_add_u32 v8, v9, 5, v8
  v_bfe_u32 v9, v0, 2, 2
  s_lshl_b32 s4, s75, 7
  s_and_b32 s5, s3, 1
  s_lshl_b32 s5, s5, 2
  s_add_u32 s4, s4, s5
  v_add_u32 v8, s4, v8
  v_lshlrev_b32 v8, 7, v8
  v_and_b32 v10, 3, v0
  v_lshl_add_u32 v8, v10, 3, v8
  v_add_u32 v8, 94208, v8
  ds_read_b64_tr_b16 v[96:97], v8 offset:0
  ds_read_b64_tr_b16 v[98:99], v8 offset:2048
  ds_read_b64_tr_b16 v[100:101], v8 offset:8192
  ds_read_b64_tr_b16 v[102:103], v8 offset:10240
  ds_read_b64_tr_b16 v[104:105], v8 offset:32
  ds_read_b64_tr_b16 v[106:107], v8 offset:2080
  ds_read_b64_tr_b16 v[108:109], v8 offset:8224
  ds_read_b64_tr_b16 v[110:111], v8 offset:10272
  ds_read_b64_tr_b16 v[112:113], v8 offset:64
  ds_read_b64_tr_b16 v[114:115], v8 offset:2112
  ds_read_b64_tr_b16 v[116:117], v8 offset:8256
  ds_read_b64_tr_b16 v[118:119], v8 offset:10304
  ds_read_b64_tr_b16 v[120:121], v8 offset:96
  ds_read_b64_tr_b16 v[122:123], v8 offset:2144
  ds_read_b64_tr_b16 v[124:125], v8 offset:8288
  ds_read_b64_tr_b16 v[126:127], v8 offset:10336
  v_lshlrev_b32 v3, 2, v0
  s_lshl_b32 s4, s3, 9
  s_add_u32 s4, s4, 159744
  v_add_u32 v42, s4, v3
  v_lshlrev_b32 v43, 3, v0
  v_add_u32 v43, 159744, v43
  s_mul_i32 s4, s77, 1056
  s_add_u32 s4, s4, 28672
  v_add_u32 v52, s4, v40
  v_lshl_add_u32 v54, v4, 2, v9
  v_mul_u32_u24 v54, 1056, v54
  v_lshl_add_u32 v54, v10, 3, v54
  s_lshl_b32 s4, s3, 7
  s_add_u32 s4, s4, 28672
  v_add_u32 v54, s4, v54
  v_and_b32 v55, 1, v0
  v_lshlrev_b32 v55, 6, v55
  v_lshl_add_u32 v55, v4, 4, v55
  s_lshl_b32 s4, s75, 7
  s_add_u32 s4, s4, 62464
  v_add_u32 v55, s4, v55
  v_mov_b32 v56, 62976
  v_and_b32 v57, 2, v0
  v_cmp_eq_u32 vcc, 0, v57
  s_nop 1
  v_cndmask_b32 v61, v55, v56, vcc
  v_cndmask_b32 v55, v56, v55, vcc
  v_lshrrev_b32 v57, 1, v57
  v_mul_u32_u24 v62, 0xaaaa, v57
  v_add_u32 v62, 0x4444, v62
  v_mov_b32 v64, 0
  v_mov_b32 v65, 0
  v_mov_b32 v66, 0
  v_mov_b32 v67, 0
  v_mov_b32 v68, 0
  v_mov_b32 v69, 0
  v_mov_b32 v70, 0
  v_mov_b32 v71, 0
  v_mov_b32 v72, 0
  v_mov_b32 v73, 0
  v_mov_b32 v74, 0
  v_mov_b32 v75, 0
  v_mov_b32 v76, 0
  v_mov_b32 v77, 0
  v_mov_b32 v78, 0
  v_mov_b32 v79, 0
  ds_write_b128 v56, v[64:67]
  v_and_b32 v53, 1, v4
  v_mul_u32_u24 v53, 72, v53
  v_lshl_add_u32 v53, v9, 4, v53
  v_lshl_add_u32 v53, v10, 1, v53
  v_lshrrev_b32 v11, 5, v0
  v_lshl_add_u32 v53, v11, 7, v53
  s_and_b32 s4, s7, 1
  s_lshl_b32 s4, s4, 8
  s_add_u32 s4, s4, 62464
  v_add_u32 v53, s4, v53
  s_bitcmp1_b32 s70, 4
  s_cbranch_scc0 sk_66
  v_add_u32 v11, s4, v3
  ds_write_b32 v11, v5
sk_66:
  s_lshl_b32 s6, s64, 11
  s_lshl_b32 s4, s63, 2
  s_add_u32 s4, s4, s62
  s_sub_u32 s4, s4, 3
  s_lshl_b32 s4, s4, 8
  s_add_u32 s6, s6, s4
  s_and_b32 s4, s6, 0xffffe000
  s_add_u32 s6, s6, s4
  s_add_u32 s6, s6, 655360
  s_cbranch_execz nb_102
  s_barrier
nb_102:
  s_bitcmp1_b32 s70, 4
  s_cbranch_scc0 sk_67
  buffer_load_dword v60, v41, s[16:19], s68 offen sc1
sk_67:
  buffer_load_dwordx4 v[160:163], v40, s[16:19], s67 offen offset:0 sc1
  buffer_load_dwordx4 v[164:167], v40, s[16:19], s67 offen offset:1024 sc1
  buffer_load_dwordx4 v[168:171], v40, s[16:19], s67 offen offset:2048 sc1
  buffer_load_dwordx4 v[172:175], v40, s[16:19], s67 offen offset:3072 sc1
  s_cbranch_execz t1a_63
  s_branch t1b_64
t1a_63:
  s_cbranch_execz nb_103
  s_barrier
nb_103:
  s_bitcmp1_b32 s70, 4
  s_cbranch_scc0 sk_68
  buffer_load_dword v60, v41, s[16:19], s68 offen sc1
sk_68:
  buffer_load_dwordx4 v[160:163], v40, s[16:19], s67 offen offset:0 sc1
  buffer_load_dwordx4 v[164:167], v40, s[16:19], s67 offen offset:1024 sc1
  buffer_load_dwordx4 v[168:171], v40, s[16:19], s67 offen offset:2048 sc1
  buffer_load_dwordx4 v[172:175], v40, s[16:19], s67 offen offset:3072 sc1
  v_bfe_u32 v9, v0, 2, 1
  v_lshlrev_b32 v8, 3, v9
  v_bfe_u32 v9, v0, 3, 1
  v_lshl_add_u32 v8, v9, 1, v8
  v_and_b32 v9, 1, v4
  v_add_u32 v8, v8, v9
  v_lshrrev_b32 v9, 5, v0
  v_lshl_add_u32 v8, v9, 5, v8
  v_bfe_u32 v9, v0, 2, 2
  s_lshl_b32 s4, s75, 7
  s_and_b32 s5, s3, 1
  s_lshl_b32 s5, s5, 2
  s_add_u32 s4, s4, s5
  v_add_u32 v8, s4, v8
  v_lshlrev_b32 v8, 7, v8
  v_and_b32 v10, 3, v0
  v_lshl_add_u32 v8, v10, 3, v8
  v_add_u32 v8, 94208, v8
  ds_read_b64_tr_b16 v[96:97], v8 offset:0
  ds_read_b64_tr_b16 v[98:99], v8 offset:2048
  ds_read_b64_tr_b16 v[100:101], v8 offset:8192
  ds_read_b64_tr_b16 v[102:103], v8 offset:10240
  ds_read_b64_tr_b16 v[104:105], v8 offset:32
  ds_read_b64_tr_b16 v[106:107], v8 offset:2080
  ds_read_b64_tr_b16 v[108:109], v8 offset:8224
  ds_read_b64_tr_b16 v[110:111], v8 offset:10272
  ds_read_b64_tr_b16 v[112:113], v8 offset:64
  ds_read_b64_tr_b16 v[114:115], v8 offset:2112
  ds_read_b64_tr_b16 v[116:117], v8 offset:8256
  ds_read_b64_tr_b16 v[118:119], v8 offset:10304
  ds_read_b64_tr_b16 v[120:121], v8 offset:96
  ds_read_b64_tr_b16 v[122:123], v8 offset:2144
  ds_read_b64_tr_b16 v[124:125], v8 offset:8288
  ds_read_b64_tr_b16 v[126:127], v8 offset:10336
  v_lshlrev_b32 v3, 2, v0
  s_lshl_b32 s4, s3, 9
  s_add_u32 s4, s4, 159744
  v_add_u32 v42, s4, v3
  v_lshlrev_b32 v43, 3, v0
  v_add_u32 v43, 159744, v43
  s_mul_i32 s4, s77, 1056
  s_add_u32 s4, s4, 28672
  v_add_u32 v52, s4, v40
  v_lshl_add_u32 v54, v4, 2, v9
  v_mul_u32_u24 v54, 1056, v54
  v_lshl_add_u32 v54, v10, 3, v54
  s_lshl_b32 s4, s3, 7
  s_add_u32 s4, s4, 28672
  v_add_u32 v54, s4, v54
  v_and_b32 v55, 1, v0
  v_lshlrev_b32 v55, 6, v55
  v_lshl_add_u32 v55, v4, 4, v55
  s_lshl_b32 s4, s75, 7
  s_add_u32 s4, s4, 62464
  v_add_u32 v55, s4, v55
  v_mov_b32 v56, 62976
  v_and_b32 v57, 2, v0
  v_cmp_eq_u32 vcc, 0, v57
  s_nop 1
  v_cndmask_b32 v61, v55, v56, vcc
  v_cndmask_b32 v55, v56, v55, vcc
  v_lshrrev_b32 v57, 1, v57
  v_mul_u32_u24 v62, 0xaaaa, v57
  v_add_u32 v62, 0x4444, v62
  v_mov_b32 v64, 0
  v_mov_b32 v65, 0
  v_mov_b32 v66, 0
  v_mov_b32 v67, 0
  v_mov_b32 v68, 0
  v_mov_b32 v69, 0
  v_mov_b32 v70, 0
  v_mov_b32 v71, 0
  v_mov_b32 v72, 0
  v_mov_b32 v73, 0
  v_mov_b32 v74, 0
  v_mov_b32 v75, 0
  v_mov_b32 v76, 0
  v_mov_b32 v77, 0
  v_mov_b32 v78, 0
  v_mov_b32 v79, 0
  ds_write_b128 v56, v[64:67]
  v_and_b32 v53, 1, v4
  v_mul_u32_u24 v53, 72, v53
  v_lshl_add_u32 v53, v9, 4, v53
  v_lshl_add_u32 v53, v10, 1, v53
  v_lshrrev_b32 v11, 5, v0
  v_lshl_add_u32 v53, v11, 7, v53
  s_and_b32 s4, s7, 1
  s_lshl_b32 s4, s4, 8
  s_add_u32 s4, s4, 62464
  v_add_u32 v53, s4, v53
  s_bitcmp1_b32 s70, 4
  s_cbranch_scc0 sk_69
  v_add_u32 v11, s4, v3
  ds_write_b32 v11, v5
sk_69:
  s_lshl_b32 s6, s64, 11
  s_lshl_b32 s4, s63, 2
  s_add_u32 s4, s4, s62
  s_sub_u32 s4, s4, 3
  s_lshl_b32 s4, s4, 8
  s_add_u32 s6, s6, s4
  s_and_b32 s4, s6, 0xffffe000
  s_add_u32 s6, s6, s4
  s_add_u32 s6, s6, 655360
t1b_64:
  s_branch pchk_70
poll_71:
  s_bitcmp1_b32 s70, 4
  s_cbranch_scc0 sk_73
  buffer_load_dword v60, v41, s[16:19], s68 offen sc1
sk_73:
  s_bitcmp1_b32 s70, 0
  s_cbranch_scc0 sk_74
  buffer_load_dwordx4 v[160:163], v40, s[16:19], s67 offen offset:0 sc1
sk_74:
  s_bitcmp1_b32 s70, 1
  s_cbranch_scc0 sk_75
  buffer_load_dwordx4 v[164:167], v40, s[16:19], s67 offen offset:1024 sc1
sk_75:
  s_bitcmp1_b32 s70, 2
  s_cbranch_scc0 sk_76
  buffer_load_dwordx4 v[168:171], v40, s[16:19], s67 offen offset:2048 sc1
sk_76:
  s_bitcmp1_b32 s70, 3
  s_cbranch_scc0 sk_77
  buffer_load_dwordx4 v[172:175], v40, s[16:19], s67 offen offset:3072 sc1
sk_77:
pchk_70:
  s_waitcnt vmcnt(0)
  s_bitcmp1_b32 s70, 4
  s_cbranch_scc0 sk_78
  v_cmp_eq_u32 vcc, -1, v60
  v_max_f32_dpp v56, v60, v60 quad_perm:[1,0,3,2] row_mask:0xf bank_mask:0xf
  s_cbranch_vccnz sk_78
  s_nop 0
  v_max_f32_dpp v56, v56, v56 quad_perm:[2,3,0,1] row_mask:0xf bank_mask:0xf
  s_nop 1
  v_max_f32_dpp v56, v56, v56 row_half_mirror row_mask:0xf bank_mask:0xf
  s_nop 1
  v_max_f32_dpp v56, v56, v56 row_mirror row_mask:0xf bank_mask:0xf
  v_sub_f32 v56, v60, v56
  v_exp_f32 v56, v56
  s_nop 1
  v_add_f32_dpp v57, v56, v56 quad_perm:[1,0,3,2] row_mask:0xf bank_mask:0xf
  s_nop 1
  v_add_f32_dpp v57, v57, v57 quad_perm:[2,3,0,1] row_mask:0xf bank_mask:0xf
  s_nop 1
  v_add_f32_dpp v57, v57, v57 row_half_mirror row_mask:0xf bank_mask:0xf
  s_nop 1
  v_add_f32_dpp v57, v57, v57 row_mirror row_mask:0xf bank_mask:0xf
  v_rcp_f32 v57, v57
  s_nop 0
  v_mul_f32 v56, v56, v57
  v_cvt_pk_bf16_f32 v56, v56, v56
  ds_write_b16 v53, v56
  s_bitset0_b32 s70, 4
sk_78:
  s_bitcmp1_b32 s70, 0
  s_cbranch_scc0 sk_79
  v_max3_u32 v58, v160, v161, v162
  v_max_u32 v58, v58, v163
  v_cmp_eq_u32 vcc, -1, v58
  s_cbranch_vccnz sk_79
  ds_write_b128 v52, v[160:163] offset:0
  s_bitset0_b32 s70, 0
sk_79:
  s_bitcmp1_b32 s70, 1
  s_cbranch_scc0 sk_80
  v_max3_u32 v58, v164, v165, v166
  v_max_u32 v58, v58, v167
  v_cmp_eq_u32 vcc, -1, v58
  s_cbranch_vccnz sk_80
  ds_write_b128 v52, v[164:167] offset:1056
  s_bitset0_b32 s70, 1
sk_80:
  s_bitcmp1_b32 s70, 2
  s_cbranch_scc0 sk_81
  v_max3_u32 v58, v168, v169, v170
  v_max_u32 v58, v58, v171
  v_cmp_eq_u32 vcc, -1, v58
  s_cbranch_vccnz sk_81
  ds_write_b128 v52, v[168:171] offset:2112
  s_bitset0_b32 s70, 2
sk_81:
  s_bitcmp1_b32 s70, 3
  s_cbranch_scc0 sk_82
  v_max3_u32 v58, v172, v173, v174
  v_max_u32 v58, v58, v175
  v_cmp_eq_u32 vcc, -1, v58
  s_cbranch_vccnz sk_82
  ds_write_b128 v52, v[172:175] offset:3168
  s_bitset0_b32 s70, 3
sk_82:
  s_cmp_eq_u32 s70, 0
  s_cbranch_scc1 pdone_72
  s_sub_u32 s78, s78, 1
  s_cmp_lg_u32 s78, 0
  s_cbranch_scc1 poll_71
pdone_72:
  s_waitcnt lgkmcnt(0)
  s_cbranch_execz nb_104
  s_barrier
nb_104:
  ds_read_b128 v[16:19], v55
  ds_read_b64_tr_b16 v[128:129], v54 offset:0
  ds_read_b64_tr_b16 v[130:131], v54 offset:16896
  ds_read_b64_tr_b16 v[132:133], v54 offset:32
  ds_read_b64_tr_b16 v[134:135], v54 offset:16928
  ds_read_b128 v[20:23], v61
  ds_read_b64_tr_b16 v[136:137], v54 offset:64
  ds_read_b64_tr_b16 v[138:139], v54 offset:16960
  ds_read_b64_tr_b16 v[140:141], v54 offset:96
  ds_read_b64_tr_b16 v[142:143], v54 offset:16992
  s_waitcnt lgkmcnt(7)
  v_mfma_f32_16x16x32_bf16 v[144:147], v[128:131], v[16:19], 0
  s_waitcnt lgkmcnt(5)
  v_mfma_f32_16x16x32_bf16 v[148:151], v[132:135], v[16:19], 0
  s_waitcnt lgkmcnt(2)
  v_mfma_f32_16x16x32_bf16 v[144:147], v[136:139], v[20:23], v[144:147]
  s_waitcnt lgkmcnt(0)
  v_mfma_f32_16x16x32_bf16 v[148:151], v[140:143], v[20:23], v[148:151]
  s_nop 5
  v_cvt_pk_bf16_f32 v44, v144, v145
  v_cvt_pk_bf16_f32 v45, v146, v147
  v_cvt_pk_bf16_f32 v46, v148, v149
  v_cvt_pk_bf16_f32 v47, v150, v151
  s_nop 1
  v_smfmac_f32_16x16x64_bf16 v[64:67], v[44:47], v[96:103], v62
  v_smfmac_f32_16x16x64_bf16 v[68:71], v[44:47], v[104:111], v62
  v_smfmac_f32_16x16x64_bf16 v[72:75], v[44:47], v[112:119], v62
  v_smfmac_f32_16x16x64_bf16 v[76:79], v[44:47], v[120:127], v62
  s_and_b64 exec, s[100:101], 0xffff
  s_nop 3
  v_pk_add_f32 v[64:65], v[64:65], v[66:67]
  ds_write2_b32 v42, v64, v65 offset0:0 offset1:64
  v_pk_add_f32 v[68:69], v[68:69], v[70:71]
  ds_write2_b32 v42, v68, v69 offset0:16 offset1:80
  v_pk_add_f32 v[72:73], v[72:73], v[74:75]
  ds_write2_b32 v42, v72, v73 offset0:32 offset1:96
  v_pk_add_f32 v[76:77], v[76:77], v[78:79]
  ds_write2_b32 v42, v76, v77 offset0:48 offset1:112
  s_mov_b64 exec, s[100:101]
  s_waitcnt lgkmcnt(0)
  s_cbranch_execz nb_105
  s_barrier
nb_105:
  s_cmp_ge_u32 s3, 1
  s_cbranch_scc1 L_fin
  ds_read2st64_b64 v[8:11], v43 offset0:0 offset1:1
  ds_read2st64_b64 v[12:15], v43 offset0:2 offset1:3
  ds_read2st64_b64 v[16:19], v43 offset0:4 offset1:5
  ds_read2st64_b64 v[20:23], v43 offset0:6 offset1:7
  s_waitcnt lgkmcnt(0)
  v_pk_add_f32 v[8:9], v[8:9], v[10:11]
  v_pk_add_f32 v[12:13], v[12:13], v[14:15]
  v_pk_add_f32 v[16:17], v[16:17], v[18:19]
  v_pk_add_f32 v[20:21], v[20:21], v[22:23]
  v_pk_add_f32 v[8:9], v[8:9], v[12:13]
  v_pk_add_f32 v[16:17], v[16:17], v[20:21]
  v_pk_add_f32 v[8:9], v[8:9], v[16:17]
  v_cvt_pk_bf16_f32 v16, v8, v9
  buffer_store_dword v16, v3, s[16:19], s6 offen sc1
  s_add_u32 s6, s6, 8192
  buffer_store_dword v16, v3, s[16:19], s6 offen sc1
  s_branch L_fin
L_t2:
  s_sub_u32 s76, s2, 112
  ds_read_b32 v94, v5 offset:1036
  s_waitcnt lgkmcnt(0)
  v_readfirstlane_b32 s29, v94
  s_sub_u32 s4, s76, 7
  s_cmp_lt_u32 s76, 16
  s_cselect_b32 s4, s76, s4
  s_mul_i32 s5, s4, 11
  s_lshr_b32 s5, s5, 5
  s_add_u32 s4, s4, s5
  s_sub_u32 s5, s76, 16
  s_lshl_b32 s6, s5, 2
  s_add_u32 s6, s6, 3
  s_cmp_lt_u32 s5, 7
  s_cselect_b32 s76, s6, s4
  v_lshrrev_b32 v8, 3, v0
  v_and_b32 v9, 7, v0
  v_mul_u32_u24 v12, 3584, v8
  v_xor_b32 v11, 6, v9
  v_lshl_add_u32 v11, v11, 4, v12
  v_xor_b32 v10, 4, v9
  v_lshl_add_u32 v10, v10, 4, v12
  v_xor_b32 v13, 2, v9
  v_lshl_add_u32 v13, v13, 4, v12
  v_xor_b32 v8, 0, v9
  v_lshl_add_u32 v8, v8, 4, v12
  v_mov_b32 v9, v13
  s_mov_b32 s20, s44
  s_mov_b32 s21, s45
  s_mov_b32 s22, 1835008
  s_mov_b32 s23, 0x20000
  s_lshl_b32 s69, s76, 7
  s_mul_i32 s67, s3, 229376
  s_add_u32 s69, s69, s67
  s_lshl_b32 s68, s3, 13
  s_add_u32 s68, s68, 28672
  s_mov_b32 m0, s68
  s_add_u32 s68, s68, 1024
  buffer_load_dwordx4 v8, s[20:23], s69 offen nt lds
  s_add_u32 s69, s69, 28672
  s_mov_b32 m0, s68
  s_add_u32 s68, s68, 1024
  buffer_load_dwordx4 v8, s[20:23], s69 offen nt lds
  s_add_u32 s69, s69, 28672
  s_mov_b32 m0, s68
  s_add_u32 s68, s68, 1024
  buffer_load_dwordx4 v9, s[20:23], s69 offen nt lds
  s_add_u32 s69, s69, 28672
  s_mov_b32 m0, s68
  s_add_u32 s68, s68, 1024
  buffer_load_dwordx4 v9, s[20:23], s69 offen nt lds
  s_add_u32 s69, s69, 28672
  s_mov_b32 m0, s68
  s_add_u32 s68, s68, 1024
  buffer_load_dwordx4 v10, s[20:23], s69 offen nt lds
  s_add_u32 s69, s69, 28672
  s_mov_b32 m0, s68
  s_add_u32 s68, s68, 1024
  buffer_load_dwordx4 v10, s[20:23], s69 offen nt lds
  s_add_u32 s69, s69, 28672
  s_mov_b32 m0, s68
  s_add_u32 s68, s68, 1024
  buffer_load_dwordx4 v11, s[20:23], s69 offen nt lds
  s_add_u32 s69, s69, 28672
  s_mov_b32 m0, s68
  s_add_u32 s68, s68, 1024
  buffer_load_dwordx4 v11, s[20:23], s69 offen nt lds
  s_add_u32 s69, s69, 28672
  s_mov_b32 s24, s46
  s_mov_b32 s25, s47
  s_mov_b32 s26, 1835008
  s_mov_b32 s27, 0x20000
  s_lshl_b32 s69, s76, 7
  s_mul_i32 s67, s3, 229376
  s_add_u32 s69, s69, s67
  s_lshl_b32 s68, s3, 13
  s_add_u32 s68, s68, 94208
  s_mov_b32 m0, s68
  s_add_u32 s68, s68, 1024
  buffer_load_dwordx4 v8, s[24:27], s69 offen nt lds
  s_add_u32 s69, s69, 28672
  s_mov_b32 m0, s68
  s_add_u32 s68, s68, 1024
  buffer_load_dwordx4 v8, s[24:27], s69 offen nt lds
  s_add_u32 s69, s69, 28672
  s_mov_b32 m0, s68
  s_add_u32 s68, s68, 1024
  buffer_load_dwordx4 v9, s[24:27], s69 offen nt lds
  s_add_u32 s69, s69, 28672
  s_mov_b32 m0, s68
  s_add_u32 s68, s68, 1024
  buffer_load_dwordx4 v9, s[24:27], s69 offen nt lds
  s_add_u32 s69, s69, 28672
  s_mov_b32 m0, s68
  s_add_u32 s68, s68, 1024
  buffer_load_dwordx4 v10, s[24:27], s69 offen nt lds
  s_add_u32 s69, s69, 28672
  s_mov_b32 m0, s68
  s_add_u32 s68, s68, 1024
  buffer_load_dwordx4 v10, s[24:27], s69 offen nt lds
  s_add_u32 s69, s69, 28672
  s_mov_b32 m0, s68
  s_add_u32 s68, s68, 1024
  buffer_load_dwordx4 v11, s[24:27], s69 offen nt lds
  s_add_u32 s69, s69, 28672
  s_mov_b32 m0, s68
  s_add_u32 s68, s68, 1024
  buffer_load_dwordx4 v11, s[24:27], s69 offen nt lds
  s_add_u32 s69, s69, 28672
  v_lshrrev_b32 v4, 4, v0
  v_bfe_u32 v16, v0, 2, 1
  v_bfe_u32 v17, v0, 3, 1
  v_lshl_add_u32 v16, v17, 5, v16
  v_bfe_u32 v17, v0, 4, 1
  v_lshl_add_u32 v16, v17, 4, v16
  v_lshrrev_b32 v17, 5, v0
  v_lshl_add_u32 v16, v17, 2, v16
  v_and_b32 v17, 3, v0
  s_lshl_b32 s4, s3, 6
  v_add_u32 v16, s4, v16
  v_lshlrev_b32 v17, 3, v17
  v_lshl_add_u32 v16, v16, 7, v17
  v_add_u32 v16, 28672, v16
  v_bfe_u32 v17, v0, 4, 1
  v_bfe_u32 v18, v0, 3, 1
  v_lshl_add_u32 v17, v18, 1, v17
  v_xor_b32 v18, 0, v17
  v_lshl_add_u32 v208, v18, 5, v16
  v_add_u32 v212, 65536, v208
  v_xor_b32 v18, 1, v17
  v_lshl_add_u32 v209, v18, 5, v16
  v_add_u32 v213, 65536, v209
  v_xor_b32 v18, 2, v17
  v_lshl_add_u32 v210, v18, 5, v16
  v_add_u32 v214, 65536, v210
  v_xor_b32 v18, 3, v17
  v_lshl_add_u32 v211, v18, 5, v16
  v_add_u32 v215, 65536, v211
  v_and_b32 v18, 31, v0
  v_lshlrev_b32 v18, 1, v18
  v_add_u32 v18, s4, v18
  v_lshlrev_b32 v19, 2, v18
  v_lshrrev_b32 v20, 5, v0
  ds_read_b64 v[24:25], v19 offset:4096
  ds_read_b64 v[26:27], v19 offset:6144
  ds_read_b64 v[28:29], v19 offset:8192
  v_lshlrev_b32 v18, 1, v18
  v_lshl_add_u32 v19, v20, 10, v18
  ds_read_b32 v30, v19 offset:10240
  v_mul_u32_u24 v44, 1088, v20
  v_add_u32 v44, v44, v18
  s_lshl_b32 s4, s3, 7
  v_and_b32 v45, 1, v0
  v_mul_u32_u24 v45, 1088, v45
  v_lshl_add_u32 v45, v4, 4, v45
  v_add_u32 v45, s4, v45
  s_lshl_b32 s4, s3, 10
  v_lshlrev_b32 v46, 3, v0
  v_add_u32 v46, s4, v46
  v_and_b32 v47, 31, v0
  v_lshlrev_b32 v42, 2, v47
  v_lshlrev_b32 v47, 4, v47
  v_lshl_add_u32 v47, v20, 2, v47
  v_add_u32 v47, 4096, v47
  v_and_b32 v42, 15, v0
  v_lshlrev_b32 v42, 2, v42
  v_lshl_add_u32 v42, v20, 6, v42
  v_bfe_u32 v21, v0, 4, 1
  v_lshl_add_u32 v42, v21, 7, v42
  v_lshlrev_b32 v41, 3, v20
  v_cmp_gt_u32 vcc, 32, v0
  s_nop 1
  v_cndmask_b32 v21, 0, 16, vcc
  v_lshlrev_b32 v40, 2, v0
  s_lshl_b32 s4, s3, 8
  v_add_u32 v40, s4, v40
  s_waitcnt lgkmcnt(0)
  v_lshlrev_b32 v10, v21, v24
  v_and_b32 v10, s79, v10
  v_lshlrev_b32 v11, v21, v25
  v_and_b32 v11, s79, v11
  v_lshlrev_b32 v14, v21, v26
  v_and_b32 v14, s79, v14
  v_lshlrev_b32 v15, v21, v27
  v_and_b32 v15, s79, v15
  v_lshlrev_b32 v12, v21, v28
  v_and_b32 v12, s79, v12
  v_lshlrev_b32 v13, v21, v29
  v_and_b32 v13, s79, v13
  v_lshlrev_b32 v8, 16, v30
  v_and_b32 v9, s79, v30
  v_add_f32 v12, 1.0, v12
  v_add_f32 v13, 1.0, v13
  v_cvt_pk_bf16_f32 v16, v12, v13
  v_lshlrev_b32 v12, 16, v16
  v_and_b32 v13, s79, v16
  v_cvt_pk_bf16_f32 v17, v14, v15
  v_add_u32 v18, 158208, v44
  ds_write_b32 v44, v16 offset:1536
  ds_write_b32 v18, v17 offset:1536
  v_bfe_u32 v18, v0, 1, 1
  v_mul_u32_u24 v18, 158208, v18
  v_add_u32 v18, v18, v45
  v_lshlrev_b32 v19, 4, v0
  s_lshl_b32 s4, s3, 11
  v_add_u32 v19, s4, v19
  s_waitcnt lgkmcnt(0)
  v_lshlrev_b32 v20, 4, v4
  v_sub_u32 v18, v18, v20
  v_bfe_u32 v20, v0, 4, 1
  v_lshl_add_u32 v18, v20, 5, v18
  v_lshrrev_b32 v20, 5, v0
  v_lshl_add_u32 v18, v20, 3, v18
  v_add_u32 v18, 1536, v18
  ds_read2_b32 v[48:49], v18 offset0:0 offset1:16
  ds_read2_b32 v[50:51], v18 offset0:1 offset1:17
  ds_read2_b32 v[52:53], v18 offset0:4 offset1:20
  ds_read2_b32 v[54:55], v18 offset0:5 offset1:21
  v_bfe_u32 v24, v0, 1, 2
  v_bfe_u32 v31, v0, 2, 1
  v_and_b32 v25, 2, v0
  v_add_u32 v31, v31, v25
  v_lshlrev_b32 v25, 5, v31
  v_lshl_add_u32 v25, v4, 3, v25
  s_lshl_b32 s4, s3, 7
  v_add_u32 v25, s4, v25
  v_and_b32 v26, 1, v0
  v_lshlrev_b32 v27, 1, v25
  v_lshl_add_u32 v28, v26, 10, v25
  v_mul_u32_u24 v29, 1088, v26
  v_add_u32 v29, v29, v25
  ds_read_b128 v[168:171], v27 offset:4096
  ds_read_b64 v[8:9], v28 offset:10240
  ds_read_b64 v[10:11], v29 offset:1536
  v_lshlrev_b32 v13, 10, v26
  ds_read_u16 v12, v13 offset:10240
  s_and_b32 s4, s3, 1
  s_lshl_b32 s4, s4, 10
  v_mov_b32 v13, s4
  ds_read_u16 v38, v13 offset:10240
  v_lshlrev_b32 v40, 5, v31
  v_lshl_add_u32 v40, v26, 7, v40
  v_lshrrev_b32 v27, 5, v0
  v_lshl_add_u32 v40, v27, 4, v40
  v_bfe_u32 v28, v0, 4, 1
  v_lshl_add_u32 v40, v28, 11, v40
  v_bfe_u32 v28, v0, 3, 1
  v_lshl_add_u32 v40, v28, 14, v40
  s_lshl_b32 s4, s3, 8
  v_add_u32 v40, s4, v40
  v_lshlrev_b32 v29, 4, v26
  v_mov_b32 v30, 0x3f80
  v_lshlrev_b32 v30, v29, v30
  v_cmp_eq_u32 vcc, v27, v28
  s_nop 1
  v_cndmask_b32 v30, 0, v30, vcc
  v_cmp_eq_u32 vcc, 0, v24
  s_nop 1
  v_cndmask_b32 v220, 0, v30, vcc
  v_cmp_eq_u32 vcc, 1, v24
  s_nop 1
  v_cndmask_b32 v221, 0, v30, vcc
  v_cmp_eq_u32 vcc, 2, v24
  s_nop 1
  v_cndmask_b32 v222, 0, v30, vcc
  v_cmp_eq_u32 vcc, 3, v24
  s_nop 1
  v_cndmask_b32 v223, 0, v30, vcc
  v_lshlrev_b32 v45, 3, v26
  v_sub_u32 v29, 16, v29
  s_waitcnt lgkmcnt(0)
  v_lshlrev_b32 v168, v29, v168
  v_and_b32 v168, s79, v168
  v_lshlrev_b32 v169, v29, v169
  v_and_b32 v169, s79, v169
  v_lshlrev_b32 v170, v29, v170
  v_and_b32 v170, s79, v170
  v_lshlrev_b32 v171, v29, v171
  v_and_b32 v171, s79, v171
  v_lshlrev_b32 v172, 16, v8
  v_and_b32 v173, s79, v8
  v_lshlrev_b32 v216, 16, v10
  v_and_b32 v217, s79, v10
  v_lshlrev_b32 v174, 16, v9
  v_and_b32 v175, s79, v9
  v_lshlrev_b32 v218, 16, v11
  v_and_b32 v219, s79, v11
  v_lshlrev_b32 v12, 16, v12
  v_lshlrev_b32 v38, 16, v38
  v_sub_f32 v172, v172, v12
  v_sub_f32 v173, v173, v12
  v_sub_f32 v174, v174, v12
  v_sub_f32 v175, v175, v12
  s_cbranch_execz nb_106
  s_barrier
nb_106:
  s_waitcnt vmcnt(8)
  ds_read_b64_tr_b16 v[96:97], v208 offset:0
  ds_read_b64_tr_b16 v[98:99], v208 offset:256
  ds_read_b64_tr_b16 v[104:105], v209 offset:0
  ds_read_b64_tr_b16 v[106:107], v209 offset:256
  ds_read_b64_tr_b16 v[112:113], v210 offset:0
  ds_read_b64_tr_b16 v[114:115], v210 offset:256
  ds_read_b64_tr_b16 v[120:121], v211 offset:0
  ds_read_b64_tr_b16 v[122:123], v211 offset:256
  ds_read_b64_tr_b16 v[100:101], v208 offset:1024
  ds_read_b64_tr_b16 v[102:103], v208 offset:1280
  ds_read_b64_tr_b16 v[108:109], v209 offset:1024
  ds_read_b64_tr_b16 v[110:111], v209 offset:1280
  ds_read_b64_tr_b16 v[116:117], v210 offset:1024
  ds_read_b64_tr_b16 v[118:119], v210 offset:1280
  ds_read_b64_tr_b16 v[124:125], v211 offset:1024
  ds_read_b64_tr_b16 v[126:127], v211 offset:1280
  s_waitcnt lgkmcnt(0)
  v_mfma_f32_16x16x32_bf16 v[176:179], v[48:51], v[96:99], 0
  v_mfma_f32_16x16x32_bf16 v[180:183], v[48:51], v[104:107], 0
  v_mfma_f32_16x16x32_bf16 v[184:187], v[48:51], v[112:115], 0
  v_mfma_f32_16x16x32_bf16 v[188:191], v[48:51], v[120:123], 0
  v_mfma_f32_16x16x32_bf16 v[176:179], v[52:55], v[100:103], v[176:179]
  v_mfma_f32_16x16x32_bf16 v[180:183], v[52:55], v[108:111], v[180:183]
  v_mfma_f32_16x16x32_bf16 v[184:187], v[52:55], v[116:119], v[184:187]
  v_mfma_f32_16x16x32_bf16 v[188:191], v[52:55], v[124:127], v[188:191]
  s_waitcnt vmcnt(0)
  ds_read_b64_tr_b16 v[128:129], v212 offset:0
  ds_read_b64_tr_b16 v[130:131], v212 offset:256
  ds_read_b64_tr_b16 v[136:137], v213 offset:0
  ds_read_b64_tr_b16 v[138:139], v213 offset:256
  ds_read_b64_tr_b16 v[144:145], v214 offset:0
  ds_read_b64_tr_b16 v[146:147], v214 offset:256
  ds_read_b64_tr_b16 v[152:153], v215 offset:0
  ds_read_b64_tr_b16 v[154:155], v215 offset:256
  ds_read_b64_tr_b16 v[132:133], v212 offset:1024
  ds_read_b64_tr_b16 v[134:135], v212 offset:1280
  ds_read_b64_tr_b16 v[140:141], v213 offset:1024
  ds_read_b64_tr_b16 v[142:143], v213 offset:1280
  ds_read_b64_tr_b16 v[148:149], v214 offset:1024
  ds_read_b64_tr_b16 v[150:151], v214 offset:1280
  ds_read_b64_tr_b16 v[156:157], v215 offset:1024
  ds_read_b64_tr_b16 v[158:159], v215 offset:1280
  s_waitcnt lgkmcnt(0)
  v_mfma_f32_16x16x32_bf16 v[192:195], v[48:51], v[128:131], 0
  v_mfma_f32_16x16x32_bf16 v[196:199], v[48:51], v[136:139], 0
  v_mfma_f32_16x16x32_bf16 v[200:203], v[48:51], v[144:147], 0
  v_mfma_f32_16x16x32_bf16 v[204:207], v[48:51], v[152:155], 0
  v_mfma_f32_16x16x32_bf16 v[192:195], v[52:55], v[132:135], v[192:195]
  v_mfma_f32_16x16x32_bf16 v[196:199], v[52:55], v[140:143], v[196:199]
  v_mfma_f32_16x16x32_bf16 v[200:203], v[52:55], v[148:151], v[200:203]
  v_mfma_f32_16x16x32_bf16 v[204:207], v[52:55], v[156:159], v[204:207]
  s_and_b64 exec, s[100:101], 0xffff
  ds_write_b128 v19, v[176:179] offset:12288
  ds_write_b128 v19, v[180:183] offset:12544
  ds_write_b128 v19, v[184:187] offset:12800
  ds_write_b128 v19, v[188:191] offset:13056
  ds_write_b128 v19, v[192:195] offset:13312
  ds_write_b128 v19, v[196:199] offset:13568
  ds_write_b128 v19, v[200:203] offset:13824
  ds_write_b128 v19, v[204:207] offset:14080
  s_mov_b64 exec, s[100:101]
  s_waitcnt lgkmcnt(0)
  s_cbranch_execz nb_107
  s_barrier
nb_107:
  s_add_u32 s67, s29, 655360
  s_add_u32 s68, s29, 659456
  s_add_u32 s69, s29, 671744
  s_add_u32 s70, s29, 675840
  s_mov_b32 s78, 400000
  buffer_load_dwordx4 v[160:163], v40, s[16:19], s67 offen sc1
  buffer_load_dwordx4 v[164:167], v40, s[16:19], s68 offen sc1
  s_cmp_ge_u32 s3, 2
  s_cbranch_scc1 nout_86
  v_lshlrev_b32 v16, 5, v0
  s_lshl_b32 s4, s3, 2
  s_add_u32 s4, s4, 12288
  v_add_u32 v16, s4, v16
  ds_read2_b32 v[64:65], v16 offset0:0 offset1:4
  ds_read2_b32 v[80:81], v16 offset0:2 offset1:6
  v_add_u32 v16, 2048, v16
  ds_read2_b32 v[66:67], v16 offset0:0 offset1:4
  ds_read2_b32 v[82:83], v16 offset0:2 offset1:6
  v_add_u32 v16, 2048, v16
  ds_read2_b32 v[68:69], v16 offset0:0 offset1:4
  ds_read2_b32 v[84:85], v16 offset0:2 offset1:6
  v_add_u32 v16, 2048, v16
  ds_read2_b32 v[70:71], v16 offset0:0 offset1:4
  ds_read2_b32 v[86:87], v16 offset0:2 offset1:6
  v_add_u32 v16, 2048, v16
  ds_read2_b32 v[72:73], v16 offset0:0 offset1:4
  ds_read2_b32 v[88:89], v16 offset0:2 offset1:6
  v_add_u32 v16, 2048, v16
  ds_read2_b32 v[74:75], v16 offset0:0 offset1:4
  ds_read2_b32 v[90:91], v16 offset0:2 offset1:6
  v_add_u32 v16, 2048, v16
  ds_read2_b32 v[76:77], v16 offset0:0 offset1:4
  ds_read2_b32 v[92:93], v16 offset0:2 offset1:6
  v_add_u32 v16, 2048, v16
  ds_read2_b32 v[78:79], v16 offset0:0 offset1:4
  ds_read2_b32 v[94:95], v16 offset0:2 offset1:6
  v_mov_b32 v36, 0xc0135761
  v_mov_b32 v37, 0xbdd2d3e8
  s_lshl_b32 s4, s3, 3
  v_mov_b32 v41, s4
  s_lshl_b32 s4, s3, 9
  s_add_u32 s4, s4, 4096
  v_lshlrev_b32 v47, 3, v0
  v_add_u32 v47, s4, v47
  v_and_b32 v42, 1, v0
  v_lshlrev_b32 v42, 6, v42
  v_bfe_u32 v17, v0, 3, 2
  v_lshl_add_u32 v42, v17, 4, v42
  v_bfe_u32 v17, v0, 1, 2
  v_lshl_add_u32 v42, v17, 2, v42
  s_lshl_b32 s77, s76, 1
  s_add_u32 s77, s77, s3
  s_lshl_b32 s77, s77, 7
  s_add_u32 s77, s77, 688128
  s_waitcnt lgkmcnt(0)
  v_pk_add_f32 v[64:65], v[64:65], v[66:67]
  v_pk_add_f32 v[68:69], v[68:69], v[70:71]
  v_pk_add_f32 v[72:73], v[72:73], v[74:75]
  v_pk_add_f32 v[76:77], v[76:77], v[78:79]
  v_pk_add_f32 v[64:65], v[64:65], v[68:69]
  v_pk_add_f32 v[72:73], v[72:73], v[76:77]
  v_pk_add_f32 v[32:33], v[64:65], v[72:73]
  v_pk_add_f32 v[80:81], v[80:81], v[82:83]
  v_pk_add_f32 v[84:85], v[84:85], v[86:87]
  v_pk_add_f32 v[88:89], v[88:89], v[90:91]
  v_pk_add_f32 v[92:93], v[92:93], v[94:95]
  v_pk_add_f32 v[80:81], v[80:81], v[84:85]
  v_pk_add_f32 v[88:89], v[88:89], v[92:93]
  v_pk_add_f32 v[34:35], v[80:81], v[88:89]
nout_86:
  v_lshlrev_b32 v46, 2, v0
  s_lshl_b32 s4, s3, 10
  s_add_u32 s4, s4, 4096
  v_add_u32 v46, s4, v46
  v_mov_b32 v64, 0
  v_mov_b32 v65, 0
  v_mov_b32 v66, 0
  v_mov_b32 v67, 0
  v_mov_b32 v68, 0
  v_mov_b32 v69, 0
  v_mov_b32 v70, 0
  v_mov_b32 v71, 0
  v_mov_b32 v72, 0
  v_mov_b32 v73, 0
  v_mov_b32 v74, 0
  v_mov_b32 v75, 0
  v_mov_b32 v76, 0
  v_mov_b32 v77, 0
  v_mov_b32 v78, 0
  v_mov_b32 v79, 0
  v_mov_b32 v80, 0
  v_mov_b32 v81, 0
  v_mov_b32 v82, 0
  v_mov_b32 v83, 0
  v_mov_b32 v84, 0
  v_mov_b32 v85, 0
  v_mov_b32 v86, 0
  v_mov_b32 v87, 0
  v_mov_b32 v88, 0
  v_mov_b32 v89, 0
  v_mov_b32 v90, 0
  v_mov_b32 v91, 0
  v_mov_b32 v92, 0
  v_mov_b32 v93, 0
  v_mov_b32 v94, 0
  v_mov_b32 v95, 0
  v_bfe_u32 v52, v0, 1, 1
  v_mul_u32_u24 v52, 0xaaaa, v52
  v_add_u32 v52, 0x4444, v52
  s_branch pchk_85
poll_83:
  s_mov_b64 exec, s[20:21]
  s_cbranch_execz sk_87
  buffer_load_dwordx4 v[160:163], v40, s[16:19], s67 offen sc1
sk_87:
  s_mov_b64 exec, s[22:23]
  s_cbranch_execz sk_88
  buffer_load_dwordx4 v[164:167], v40, s[16:19], s68 offen sc1
sk_88:
  s_mov_b64 exec, s[100:101]
pchk_85:
  s_waitcnt vmcnt(0)
  v_max3_u32 v58, v160, v161, v162
  v_max3_u32 v59, v164, v165, v166
  v_max_u32 v58, v58, v163
  v_max_u32 v59, v59, v167
  v_cmp_eq_u32 s[20:21], -1, v58
  v_cmp_eq_u32 s[22:23], -1, v59
  s_nop 0
  s_or_b64 s[4:5], s[20:21], s[22:23]
  s_cbranch_scc0 pdone_84
  s_sub_u32 s78, s78, 1
  s_cmp_lg_u32 s78, 0
  s_cbranch_scc1 poll_83
pdone_84:
  v_mfma_f32_16x16x32_bf16 v[16:19], v[220:223], v[160:163], 0
  v_mfma_f32_16x16x32_bf16 v[16:19], v[220:223], v[164:167], v[16:19]
  s_nop 7
  v_add_f32_dpp v16, v16, v16 row_ror:8 row_mask:0xf bank_mask:0xf
  v_add_f32_dpp v17, v17, v17 row_ror:8 row_mask:0xf bank_mask:0xf
  v_add_f32_dpp v18, v18, v18 row_ror:8 row_mask:0xf bank_mask:0xf
  v_add_f32_dpp v19, v19, v19 row_ror:8 row_mask:0xf bank_mask:0xf
  v_pk_fma_f32 v[16:17], v[16:17], v[168:169], v[172:173]
  v_pk_fma_f32 v[18:19], v[18:19], v[170:171], v[174:175]
  v_pk_mul_f32 v[24:25], v[16:17], v[216:217]
  v_pk_mul_f32 v[26:27], v[18:19], v[218:219]
  v_cvt_pk_bf16_f32 v48, v24, v25
  v_cvt_pk_bf16_f32 v49, v26, v27
  v_pk_mul_f32 v[20:21], v[16:17], v[16:17]
  v_mov_b32_dpp v50, v48 row_shl:4 row_mask:0xf bank_mask:0xf
  v_mov_b32_dpp v51, v49 row_shl:4 row_mask:0xf bank_mask:0xf
  s_nop 1
  v_smfmac_f32_16x16x64_bf16 v[64:67], v[48:51], v[96:103], v52
  v_pk_fma_f32 v[20:21], v[18:19], v[18:19], v[20:21]
  v_pk_add_f32 v[22:23], v[16:17], v[18:19]
  v_smfmac_f32_16x16x64_bf16 v[68:71], v[48:51], v[104:111], v52
  v_add_f32 v21, v20, v21
  v_add_f32 v22, v22, v23
  v_smfmac_f32_16x16x64_bf16 v[72:75], v[48:51], v[112:119], v52
  v_add_f32_dpp v21, v21, v21 quad_perm:[2,3,0,1] row_mask:0xf bank_mask:0xf
  v_add_f32_dpp v22, v22, v22 quad_perm:[2,3,0,1] row_mask:0xf bank_mask:0xf
  v_smfmac_f32_16x16x64_bf16 v[76:79], v[48:51], v[120:127], v52
  v_add_f32_dpp v21, v21, v21 row_ror:4 row_mask:0xf bank_mask:0xf
  v_add_f32_dpp v22, v22, v22 row_ror:4 row_mask:0xf bank_mask:0xf
  v_smfmac_f32_16x16x64_bf16 v[80:83], v[48:51], v[128:135], v52
  s_and_b32 exec_lo, s100, 0x00030003
  s_and_b32 exec_hi, s100, 0x00030003
  ds_add_f32 v45, v22 offset:1040
  ds_add_f32 v45, v21 offset:1044
  s_mov_b64 exec, s[100:101]
  v_smfmac_f32_16x16x64_bf16 v[84:87], v[48:51], v[136:143], v52
  v_smfmac_f32_16x16x64_bf16 v[88:91], v[48:51], v[144:151], v52
  v_smfmac_f32_16x16x64_bf16 v[92:95], v[48:51], v[152:159], v52
  s_and_b64 exec, s[100:101], 0xffff
  v_pk_add_f32 v[64:65], v[64:65], v[66:67]
  ds_write2_b32 v46, v64, v65 offset0:0 offset1:128
  v_pk_add_f32 v[68:69], v[68:69], v[70:71]
  ds_write2_b32 v46, v68, v69 offset0:16 offset1:144
  v_pk_add_f32 v[72:73], v[72:73], v[74:75]
  ds_write2_b32 v46, v72, v73 offset0:32 offset1:160
  v_pk_add_f32 v[76:77], v[76:77], v[78:79]
  ds_write2_b32 v46, v76, v77 offset0:48 offset1:176
  v_pk_add_f32 v[80:81], v[80:81], v[82:83]
  ds_write2_b32 v46, v80, v81 offset0:64 offset1:192
  v_pk_add_f32 v[84:85], v[84:85], v[86:87]
  ds_write2_b32 v46, v84, v85 offset0:80 offset1:208
  v_pk_add_f32 v[88:89], v[88:89], v[90:91]
  ds_write2_b32 v46, v88, v89 offset0:96 offset1:224
  v_pk_add_f32 v[92:93], v[92:93], v[94:95]
  ds_write2_b32 v46, v92, v93 offset0:112 offset1:240
  s_mov_b64 exec, s[100:101]
  s_waitcnt lgkmcnt(0)
  s_cbranch_execz nb_108
  s_barrier
nb_108:
  s_cmp_lt_u32 s3, 2
  s_cbranch_scc1 noep_89
  s_cmp_lg_u32 s2, 112
  s_cbranch_scc1 L_fin
  s_cmp_lg_u32 s3, 2
  s_cbranch_scc1 L_fin
  v_mov_b32 v27, s60
  s_and_b64 exec, s[100:101], 1
  buffer_store_dword v27, off, s[16:19], 0 sc1
  s_mov_b64 exec, s[100:101]
  s_branch L_fin
noep_89:
  ds_read_b64 v[20:21], v41 offset:1040
  ds_read2st64_b64 v[96:99], v47 offset0:0 offset1:2
  ds_read2st64_b64 v[100:103], v47 offset0:4 offset1:6
  ds_read2st64_b64 v[104:107], v47 offset0:8 offset1:10
  ds_read2st64_b64 v[108:111], v47 offset0:12 offset1:14
  s_waitcnt lgkmcnt(4)
  v_mul_f32 v20, 0x3b000000, v20
  v_mul_f32 v21, 0x3b000000, v21
  v_fma_f32 v21, -v20, v20, v21
  v_add_f32 v20, v20, v38
  v_max_f32 v21, 0, v21
  v_cvt_pk_bf16_f32 v22, v20, v21
  s_waitcnt lgkmcnt(2)
  v_pk_add_f32 v[96:97], v[96:97], v[98:99]
  v_and_b32 v21, s79, v22
  v_pk_add_f32 v[100:101], v[100:101], v[102:103]
  v_add_f32 v21, 0x3727c5ac, v21
  v_lshlrev_b32 v20, 16, v22
  v_cvt_pk_bf16_f32 v21, v21, v21
  v_pk_add_f32 v[96:97], v[96:97], v[100:101]
  v_sub_f32 v20, v20, v38
  v_lshlrev_b32 v21, 16, v21
  s_waitcnt lgkmcnt(0)
  v_pk_add_f32 v[104:105], v[104:105], v[106:107]
  v_sqrt_f32 v21, v21
  v_pk_add_f32 v[108:109], v[108:109], v[110:111]
  v_pk_fma_f32 v[96:97], v[32:33], v[20:21], v[96:97] op_sel_hi:[1,0,1] neg_lo:[1,0,0] neg_hi:[1,0,0]
  v_cvt_pk_bf16_f32 v21, v21, v21
  v_pk_add_f32 v[104:105], v[104:105], v[108:109]
  v_lshlrev_b32 v21, 16, v21
  v_rcp_f32 v22, v21
  v_pk_add_f32 v[96:97], v[96:97], v[104:105]
  v_pk_fma_f32 v[8:9], v[96:97], v[22:23], v[34:35] op_sel_hi:[1,0,1]
  v_cvt_pk_bf16_f32 v10, v8, v9
  v_lshlrev_b32 v8, 16, v10
  v_and_b32 v9, s79, v10
  v_pk_mul_f32 v[10:11], v[8:9], v[8:9]
  v_mov_b32 v12, v8
  v_pk_fma_f32 v[10:11], v[10:11], v[36:37], v[36:37] op_sel:[0,1,0] op_sel_hi:[1,1,0]
  v_mov_b32 v13, v9
  v_pk_mul_f32 v[10:11], v[10:11], v[8:9]
  v_exp_f32 v10, v10
  v_exp_f32 v11, v11
  v_permlane32_swap_b32 v12, v14
  v_permlane32_swap_b32 v13, v15
  v_add_f32 v10, 1.0, v10
  v_add_f32 v11, 1.0, v11
  v_rcp_f32 v10, v10
  v_rcp_f32 v11, v11
  s_nop 0
  v_pk_mul_f32 v[10:11], v[10:11], v[8:9]
  v_cvt_pk_bf16_f32 v16, v10, v11
  v_lshlrev_b32 v10, 16, v16
  v_and_b32 v11, s79, v16
  v_pk_mul_f32 v[10:11], v[10:11], v[14:15]
  v_cvt_pk_bf16_f32 v18, v10, v11
  s_and_b64 exec, s[100:101], 0xffffffff
  buffer_store_dword v18, v42, s[16:19], s77 offen sc1
  s_add_u32 s77, s77, 8192
  buffer_store_dword v18, v42, s[16:19], s77 offen sc1
  s_mov_b64 exec, s[100:101]
  s_branch L_fin
L_t3:
  v_mov_b32 v22, 0
  ds_read_b32 v94, v5 offset:1036
  s_waitcnt lgkmcnt(0)
  v_readfirstlane_b32 s29, v94
  s_nop 0
  s_mov_b32 s77, s29
  v_lshrrev_b32 v4, 4, v0
  s_add_u32 s4, s2, 0
  s_and_b32 s4, s4, 7
  s_lshl_b32 s4, s4, 1
  s_bfe_u32 s76, s2, 0x10003
  s_add_u32 s76, s76, s4
  s_lshl_b32 s75, s3, 8
  s_mul_i32 s4, s3, 192
  s_add_u32 s4, s4, 256
  s_cmp_lt_u32 s3, 4
  s_cselect_b32 s75, s75, s4
  s_cmp_lg_u32 s3, 0
  s_cbranch_scc1 nox2_90
  s_mov_b32 s28, s32
  s_mov_b32 s29, s33
  s_mov_b32 s30, 2048
  s_mov_b32 s31, 0x20000
  v_and_b32 v9, 15, v0
  v_lshlrev_b32 v9, 1, v9
  v_lshrrev_b32 v10, 5, v0
  v_lshlrev_b32 v23, 2, v9
  v_lshl_add_u32 v23, v10, 7, v23
  v_add_u32 v23, 159744, v23
  v_lshlrev_b32 v8, 1, v9
  v_lshl_add_u32 v8, v10, 7, v8
  s_lshr_b32 s4, s76, 1
  s_lshl_b32 s4, s4, 8
  s_and_b32 s5, s76, 1
  s_lshl_b32 s5, s5, 6
  s_add_u32 s4, s4, s5
  v_add_u32 v8, s4, v8
  s_lshl_b32 s4, s76, 5
  v_add_u32 v9, s4, v9
  v_lshlrev_b32 v22, 1, v9
  v_lshl_add_u32 v22, v10, 10, v22
  v_lshlrev_b32 v9, 3, v9
  buffer_load_dword v12, v22, s[28:31], 0 offen
  s_mov_b32 s67, 12288
  s_mov_b32 s68, 24576
  s_mov_b32 s78, 400000
poll_91:
  buffer_load_dwordx4 v[24:27], v9, s[16:19], s67 offen sc1
  buffer_load_dwordx4 v[28:31], v9, s[16:19], s68 offen sc1
  s_waitcnt vmcnt(0)
  v_min3_u32 v10, v25, v27, v29
  v_max3_u32 v11, v25, v27, v29
  v_min3_u32 v10, v10, v31, v31
  v_max3_u32 v11, v11, v31, v31
  v_xor_b32 v10, s60, v10
  v_xor_b32 v11, s60, v11
  v_or_b32 v10, v10, v11
  v_cmp_ne_u32 vcc, 0, v10
  s_cbranch_vccz pdone_92
  s_sub_u32 s78, s78, 1
  s_cmp_lg_u32 s78, 0
  s_sleep 1
  s_cbranch_scc1 poll_91
pdone_92:
  v_cmp_gt_u32 vcc, 32, v0
  s_nop 1
  v_cndmask_b32 v10, 0, 16, vcc
  v_lshlrev_b32 v14, v10, v24
  v_and_b32 v14, s79, v14
  v_lshlrev_b32 v15, v10, v26
  v_and_b32 v15, s79, v15
  v_lshlrev_b32 v20, v10, v28
  v_and_b32 v20, s79, v20
  v_lshlrev_b32 v21, v10, v30
  v_and_b32 v21, s79, v21
  v_and_b32 v13, s79, v12
  v_lshlrev_b32 v12, 16, v12
nox2_90:
  s_mov_b32 s20, s48
  s_mov_b32 s21, s49
  s_mov_b32 s22, 1835008
  s_mov_b32 s23, 0x20000
  v_lshrrev_b32 v10, 2, v0
  v_and_b32 v9, 3, v0
  v_lshlrev_b32 v9, 4, v9
  v_lshl_add_u32 v9, v10, 10, v9
  s_lshl_b32 s69, s76, 6
  s_lshl_b32 s67, s75, 10
  s_add_u32 s69, s69, s67
  s_lshl_b32 s68, s75, 6
  s_add_u32 s68, s68, 28672
  s_cmp_lt_u32 s3, 4
  s_cselect_b32 s4, 16, 12
  s_mov_b32 s70, s4
dma_93:
  s_mov_b32 m0, s68
  s_add_u32 s68, s68, 1024
  buffer_load_dwordx4 v9, s[20:23], s69 offen nt lds
  s_add_u32 s69, s69, 16384
  s_sub_u32 s70, s70, 1
  s_cmp_lg_u32 s70, 0
  s_cbranch_scc1 dma_93
  v_bfe_u32 v41, v0, 2, 2
  v_and_b32 v42, 3, v0
  v_lshl_add_u32 v41, v4, 3, v41
  s_mov_b32 s4, s75
  v_add_u32 v41, s4, v41
  v_lshlrev_b32 v42, 3, v42
  v_lshl_add_u32 v41, v41, 6, v42
  v_add_u32 v41, 28672, v41
  s_waitcnt vmcnt(0)
  ds_read_b64_tr_b16 v[96:97], v41 offset:0
  ds_read_b64_tr_b16 v[98:99], v41 offset:256
  ds_read_b64_tr_b16 v[100:101], v41 offset:2048
  ds_read_b64_tr_b16 v[102:103], v41 offset:2304
  ds_read_b64_tr_b16 v[104:105], v41 offset:32
  ds_read_b64_tr_b16 v[106:107], v41 offset:288
  ds_read_b64_tr_b16 v[108:109], v41 offset:2080
  ds_read_b64_tr_b16 v[110:111], v41 offset:2336
  ds_read_b64_tr_b16 v[112:113], v41 offset:4096
  ds_read_b64_tr_b16 v[114:115], v41 offset:4352
  ds_read_b64_tr_b16 v[116:117], v41 offset:6144
  ds_read_b64_tr_b16 v[118:119], v41 offset:6400
  ds_read_b64_tr_b16 v[120:121], v41 offset:4128
  ds_read_b64_tr_b16 v[122:123], v41 offset:4384
  ds_read_b64_tr_b16 v[124:125], v41 offset:6176
  ds_read_b64_tr_b16 v[126:127], v41 offset:6432
  ds_read_b64_tr_b16 v[128:129], v41 offset:8192
  ds_read_b64_tr_b16 v[130:131], v41 offset:8448
  ds_read_b64_tr_b16 v[132:133], v41 offset:10240
  ds_read_b64_tr_b16 v[134:135], v41 offset:10496
  ds_read_b64_tr_b16 v[136:137], v41 offset:8224
  ds_read_b64_tr_b16 v[138:139], v41 offset:8480
  ds_read_b64_tr_b16 v[140:141], v41 offset:10272
  ds_read_b64_tr_b16 v[142:143], v41 offset:10528
  s_cmp_ge_u32 s3, 4
  s_cbranch_scc1 s3_94
  ds_read_b64_tr_b16 v[144:145], v41 offset:12288
  ds_read_b64_tr_b16 v[146:147], v41 offset:12544
  ds_read_b64_tr_b16 v[148:149], v41 offset:14336
  ds_read_b64_tr_b16 v[150:151], v41 offset:14592
  ds_read_b64_tr_b16 v[152:153], v41 offset:12320
  ds_read_b64_tr_b16 v[154:155], v41 offset:12576
  ds_read_b64_tr_b16 v[156:157], v41 offset:14368
  ds_read_b64_tr_b16 v[158:159], v41 offset:14624
s3_94:
  s_cmp_lg_u32 s3, 0
  s_cbranch_scc1 nox2_95
  s_add_u32 s67, s77, 655360
  s_add_u32 s68, s77, 659456
  s_add_u32 s69, s77, 671744
  s_add_u32 s70, s77, 675840
  s_mov_b32 s78, 400000
  buffer_load_dword v160, v8, s[16:19], s67 offen offset:0 sc1
  buffer_load_dword v161, v8, s[16:19], s67 offen offset:2048 sc1
  buffer_load_dword v162, v8, s[16:19], s68 offen offset:0 sc1
  buffer_load_dword v163, v8, s[16:19], s68 offen offset:2048 sc1
  buffer_load_dword v164, v8, s[16:19], s69 offen offset:0 sc1
  buffer_load_dword v165, v8, s[16:19], s69 offen offset:2048 sc1
  buffer_load_dword v166, v8, s[16:19], s70 offen offset:0 sc1
  buffer_load_dword v167, v8, s[16:19], s70 offen offset:2048 sc1
  s_branch pchk_98
poll_96:
  s_or_b64 exec, s[20:21], 1
  buffer_load_dword v160, v8, s[16:19], s67 offen offset:0 sc1
  buffer_load_dword v161, v8, s[16:19], s67 offen offset:2048 sc1
  s_or_b64 exec, s[22:23], 1
  buffer_load_dword v162, v8, s[16:19], s68 offen offset:0 sc1
  buffer_load_dword v163, v8, s[16:19], s68 offen offset:2048 sc1
  s_or_b64 exec, s[24:25], 1
  buffer_load_dword v164, v8, s[16:19], s69 offen offset:0 sc1
  buffer_load_dword v165, v8, s[16:19], s69 offen offset:2048 sc1
  s_or_b64 exec, s[26:27], 1
  buffer_load_dword v166, v8, s[16:19], s70 offen offset:0 sc1
  buffer_load_dword v167, v8, s[16:19], s70 offen offset:2048 sc1
  s_mov_b64 exec, s[100:101]
pchk_98:
  s_waitcnt vmcnt(0)
  v_max3_u32 v58, v160, v161, v160
  v_cmp_eq_u32 s[20:21], -1, v58
  v_max3_u32 v59, v162, v163, v162
  v_cmp_eq_u32 s[22:23], -1, v59
  v_max3_u32 v58, v164, v165, v164
  v_cmp_eq_u32 s[24:25], -1, v58
  v_max3_u32 v59, v166, v167, v166
  v_cmp_eq_u32 s[26:27], -1, v59
  s_or_b64 s[4:5], s[20:21], s[22:23]
  s_or_b64 s[4:5], s[4:5], s[24:25]
  s_or_b64 s[4:5], s[4:5], s[26:27]
  s_cmp_eq_u64 s[4:5], 0
  s_cbranch_scc1 pdone_97
  s_sub_u32 s78, s78, 1
  s_cmp_lg_u32 s78, 0
  s_cbranch_scc1 poll_96
pdone_97:
  v_lshlrev_b32 v208, 16, v160
  v_and_b32 v209, s79, v160
  v_lshlrev_b32 v210, 16, v161
  v_and_b32 v211, s79, v161
  v_lshlrev_b32 v212, 16, v162
  v_and_b32 v213, s79, v162
  v_lshlrev_b32 v214, 16, v163
  v_and_b32 v215, s79, v163
  v_lshlrev_b32 v216, 16, v164
  v_and_b32 v217, s79, v164
  v_lshlrev_b32 v218, 16, v165
  v_and_b32 v219, s79, v165
  v_lshlrev_b32 v220, 16, v166
  v_and_b32 v221, s79, v166
  v_lshlrev_b32 v222, 16, v167
  v_and_b32 v223, s79, v167
  v_pk_add_f32 v[208:209], v[208:209], v[210:211]
  v_pk_add_f32 v[212:213], v[212:213], v[214:215]
  v_pk_add_f32 v[216:217], v[216:217], v[218:219]
  v_pk_add_f32 v[220:221], v[220:221], v[222:223]
  v_pk_add_f32 v[208:209], v[208:209], v[212:213]
  v_pk_add_f32 v[216:217], v[216:217], v[220:221]
  v_pk_add_f32 v[16:17], v[208:209], v[216:217]
  v_cvt_pk_bf16_f32 v18, v16, v17
  v_lshlrev_b32 v16, 16, v18
  v_and_b32 v17, s79, v18
  v_mul_f32 v16, v16, v14
  v_mul_f32 v17, v17, v15
  v_cvt_pk_bf16_f32 v18, v16, v17
  v_lshlrev_b32 v16, 16, v18
  v_and_b32 v17, s79, v18
  v_add_f32 v16, v16, v12
  v_add_f32 v17, v17, v13
  v_cvt_pk_bf16_f32 v18, v16, v17
  v_lshlrev_b32 v16, 16, v18
  v_and_b32 v17, s79, v18
nox2_95:
  s_mov_b32 s28, s54
  s_mov_b32 s29, s55
  s_mov_b32 s30, 2048
  s_mov_b32 s31, 0x20000
  s_mul_i32 s69, s3, 896
  s_add_u32 s69, s69, 688128
  v_and_b32 v8, 1, v0
  v_mul_u32_u24 v8, 64, v8
  v_lshl_add_u32 v8, v4, 4, v8
  v_lshlrev_b32 v46, 2, v0
  s_lshl_b32 s4, s3, 8
  s_add_u32 s4, s4, 159744
  v_add_u32 v46, s4, v46
  s_waitcnt lgkmcnt(0)
  s_lshl_b32 s67, s75, 2
  s_add_u32 s67, s67, s77
  s_add_u32 s67, s67, 688128
  v_and_b32 v9, 15, v0
  v_lshlrev_b32 v9, 6, v9
  v_lshl_add_u32 v8, v4, 4, v9
  v_and_b32 v9, 1, v0
  v_mul_u32_u24 v9, 0xaaaa, v9
  v_add_u32 v9, 0x4444, v9
  v_mov_b32 v48, 0
  v_mov_b32 v49, 0
  v_mov_b32 v50, 0
  v_mov_b32 v51, 0
  v_mov_b32 v52, 0
  v_mov_b32 v53, 0
  v_mov_b32 v54, 0
  v_mov_b32 v55, 0
  s_cmp_lt_u32 s3, 4
  s_cselect_b32 s6, -1, 0x0fff0fff
  s_mov_b32 s7, s6
  s_and_b64 exec, s[6:7], s[100:101]
  s_mov_b32 s78, 400000
poll_99:
  buffer_load_dwordx4 v[64:67], v8, s[16:19], s67 offen sc1
  s_and_b64 exec, s[6:7], s[100:101]
  s_waitcnt vmcnt(0)
  v_max3_u32 v58, v64, v65, v66
  v_max_u32 v58, v58, v67
  v_cmp_eq_u32 vcc, -1, v58
  s_cbranch_vccz use_100
  s_mov_b64 exec, vcc
  s_sub_u32 s78, s78, 1
  s_cmp_lg_u32 s78, 0
  s_cbranch_scc1 poll_99
use_100:
  s_mov_b64 exec, s[100:101]
  v_smfmac_f32_16x16x64_bf16 v[48:51], v[64:67], v[96:103], v9
  v_mov_b32_dpp v68, v64 row_shl:4 row_mask:0xf bank_mask:0xf
  v_mov_b32_dpp v69, v65 row_shl:4 row_mask:0xf bank_mask:0xf
  v_mov_b32_dpp v70, v66 row_shl:4 row_mask:0xf bank_mask:0xf
  v_mov_b32_dpp v71, v67 row_shl:4 row_mask:0xf bank_mask:0xf
  v_smfmac_f32_16x16x64_bf16 v[52:55], v[64:67], v[104:111], v9
  s_nop 0
  v_smfmac_f32_16x16x64_bf16 v[48:51], v[68:71], v[112:119], v9
  v_mov_b32_dpp v72, v64 row_shl:8 row_mask:0xf bank_mask:0xf
  v_mov_b32_dpp v73, v65 row_shl:8 row_mask:0xf bank_mask:0xf
  v_mov_b32_dpp v74, v66 row_shl:8 row_mask:0xf bank_mask:0xf
  v_mov_b32_dpp v75, v67 row_shl:8 row_mask:0xf bank_mask:0xf
  v_smfmac_f32_16x16x64_bf16 v[52:55], v[68:71], v[120:127], v9
  s_nop 0
  v_smfmac_f32_16x16x64_bf16 v[48:51], v[72:75], v[128:135], v9
  v_mov_b32_dpp v76, v64 row_shl:12 row_mask:0xf bank_mask:0xf
  v_mov_b32_dpp v77, v65 row_shl:12 row_mask:0xf bank_mask:0xf
  v_mov_b32_dpp v78, v66 row_shl:12 row_mask:0xf bank_mask:0xf
  v_mov_b32_dpp v79, v67 row_shl:12 row_mask:0xf bank_mask:0xf
  v_smfmac_f32_16x16x64_bf16 v[52:55], v[72:75], v[136:143], v9
  s_cmp_ge_u32 s3, 4
  s_cbranch_scc1 pd_101
  v_smfmac_f32_16x16x64_bf16 v[48:51], v[76:79], v[144:151], v9
  v_smfmac_f32_16x16x64_bf16 v[52:55], v[76:79], v[152:159], v9
pd_101:
  s_nop 6
  v_add_f32 v48, v48, v49
  v_add_f32 v49, v50, v51
  v_add_f32 v52, v52, v53
  v_add_f32 v53, v54, v55
  s_and_b64 exec, s[100:101], 0xffff
  ds_write2_b32 v46, v48, v49 offset0:0 offset1:32
  ds_write2_b32 v46, v52, v53 offset0:16 offset1:48
  s_mov_b64 exec, s[100:101]
  s_waitcnt lgkmcnt(0)
  s_cbranch_execz nb_109
  s_barrier
nb_109:
  s_cmp_lg_u32 s3, 0
  s_cbranch_scc1 L_fin
  ds_read2_b64 v[96:99], v23 offset0:0 offset1:32
  ds_read2_b64 v[100:103], v23 offset0:64 offset1:96
  ds_read2_b64 v[104:107], v23 offset0:128 offset1:160
  ds_read2_b64 v[108:111], v23 offset0:192 offset1:224
  s_and_b32 exec_lo, s100, 0xffff
  s_and_b32 exec_hi, s100, 0xffff
  s_waitcnt lgkmcnt(2)
  v_pk_add_f32 v[96:97], v[96:97], v[98:99]
  v_pk_add_f32 v[100:101], v[100:101], v[102:103]
  s_waitcnt lgkmcnt(0)
  v_pk_add_f32 v[104:105], v[104:105], v[106:107]
  v_pk_add_f32 v[108:109], v[108:109], v[110:111]
  v_pk_add_f32 v[96:97], v[96:97], v[100:101]
  v_pk_add_f32 v[104:105], v[104:105], v[108:109]
  v_pk_add_f32 v[8:9], v[96:97], v[104:105]
  v_cvt_pk_bf16_f32 v10, v8, v9
  v_lshlrev_b32 v8, 16, v10
  v_and_b32 v9, s79, v10
  v_pk_mul_f32 v[8:9], v[8:9], v[20:21]
  v_cvt_pk_bf16_f32 v10, v8, v9
  v_lshlrev_b32 v8, 16, v10
  v_and_b32 v9, s79, v10
  v_pk_add_f32 v[8:9], v[8:9], v[16:17]
  v_cvt_pk_bf16_f32 v8, v8, v9
  buffer_store_dword v8, v22, s[28:31], 0 offen sc1
  s_mov_b64 exec, s[100:101]
  s_branch L_fin
  v_cvt_pk_bf16_f32 v10, v8, v9
  v_lshlrev_b32 v8, 16, v10
  v_and_b32 v9, s79, v10
  v_mul_f32 v8, v8, v20
  v_mul_f32 v9, v9, v21
  v_cvt_pk_bf16_f32 v10, v8, v9
  v_lshlrev_b32 v8, 16, v10
  v_and_b32 v9, s79, v10
  v_add_f32 v8, v8, v16
  v_add_f32 v9, v9, v17
  v_cvt_pk_bf16_f32 v8, v8, v9
  s_and_b32 exec_lo, s100, 0xffff
  s_and_b32 exec_hi, s100, 0xffff
  buffer_store_dword v8, v22, s[28:31], 0 offen sc1
  s_mov_b64 exec, s[100:101]
L_fin:
  s_cbranch_execz L_dryret
L_end:
  s_endpgm
.set CODE_LEN, L_end - adaLN_cond__gqa_block_cached__glu_gated_geglu__decode_kernel
.section .rodata,"a"
.p2align 6
.amdhsa_kernel adaLN_cond__gqa_block_cached__glu_gated_geglu__decode_kernel
  .amdhsa_next_free_vgpr 240
  .amdhsa_next_free_sgpr 102
  .amdhsa_accum_offset 240
  .amdhsa_group_segment_fixed_size 0
  .amdhsa_kernarg_size 112
  .amdhsa_user_sgpr_count 2
  .amdhsa_user_sgpr_kernarg_segment_ptr 1
  .amdhsa_system_sgpr_workgroup_id_x 1
  .amdhsa_float_denorm_mode_32 3
.end_amdhsa_kernel
```
